```python
import torch

def _softmax(x, axis=-1):
    return torch.softmax(x, dim=axis)
def _gelu(x):
    return torch.nn.functional.gelu(x, approximate="tanh")
def _silu(x):
    return torch.nn.functional.silu(x)
def _sigmoid(x):
    return torch.sigmoid(x)
def _layernorm(x, axis=-1, eps=1e-5):
    m = x.mean(dim=axis, keepdim=True)
    v = x.var(dim=axis, keepdim=True, unbiased=False)
    return (x - m) / torch.sqrt(v + eps)
def _scatter_add(tgt, idx, src, axis=0):
    return tgt.clone().index_add_(axis, idx, src)
def _segment_sum(src, seg, n):
    out = torch.zeros((n,) + src.shape[1:], dtype=src.dtype)
    return out.index_add_(0, seg, src)
def _pad(x, pw):
    flat = tuple(v for pair in reversed(pw) for v in pair)
    return torch.nn.functional.pad(x, flat)

kernel_name = 'standalone__mha_softmax__near_ridge'

def setup_inputs():

    _w = (lambda a: (lambda t: t.to(torch.bfloat16) if t.is_floating_point() else t)(torch.as_tensor(a)))
    B, H, Sq, Sk, D = 16, 32, 256, 256, 192
    return {
        "q": _w((lambda *s: torch.randn(*s, dtype=torch.bfloat16) * 0.8)(B, H, Sq, D)),
        "k": _w((lambda *s: torch.randn(*s, dtype=torch.bfloat16) * 0.8)(B, H, Sk, D)),
        "v": _w((lambda *s: torch.randn(*s, dtype=torch.bfloat16) * 0.05)(B, H, Sk, D)),
    }

def reference(q, k, v):
    scale = q.shape[-1] ** -0.5
    scores = torch.einsum("bhqd,bhkd->bhqk", q, k) * scale
    p = _softmax(scores, axis=-1)
    return torch.einsum("bhqk,bhkd->bhqd", p, v)
```

```asm
; @launch grid=(256,1,1) block=(512,1,1) lds=163840
.amdgcn_target "amdgcn-amd-amdhsa--gfx950"
.text
.globl standalone__mha_softmax__near_ridge_kernel
.p2align 8
.type standalone__mha_softmax__near_ridge_kernel,@function
standalone__mha_softmax__near_ridge_kernel:
    s_cmp_ge_u32 s2, 256
    s_cbranch_scc1 L_end
    s_load_dwordx8 s[4:11], s[0:1], 0
    v_lshrrev_b32 v1, 6, v0
    v_and_b32 v2, 63, v0
    v_readfirstlane_b32 s35, v1
    s_mul_i32 s34, s2, 98304
    s_movk_i32 s40, 384
    v_lshrrev_b32 v3, 3, v2
    s_lshl_b32 s30, s35, 11
    s_lshl_b32 s41, s35, 4
    v_add_u32 v4, s41, v3
    v_mul_lo_u32 v4, v4, s40
    v_bfe_u32 v5, v2, 4, 1
    v_lshlrev_b32 v5, 2, v5
    v_lshrrev_b32 v6, 5, v2
    v_or_b32 v5, v5, v6
    v_and_b32 v7, 7, v2
    v_xor_b32 v8, v7, v5
    v_lshlrev_b32 v8, 4, v8
    v_add_u32 v240, v4, v8
    v_xor_b32 v8, 32, v8
    v_add_u32 v8, v4, v8
    v_add_u32 v241, 2048, v8
    s_waitcnt lgkmcnt(0)
    s_add_u32 s12, s4, s34
    s_addc_u32 s13, s5, 0
    s_and_b32 s13, s13, 0xffff
    s_mov_b32 s14, 98304
    s_mov_b32 s15, 0x20000
    s_add_u32 s16, s6, s34
    s_addc_u32 s17, s7, 0
    s_and_b32 s17, s17, 0xffff
    s_mov_b32 s18, 98304
    s_mov_b32 s19, 0x20000
    s_mov_b32 m0, s30
    s_nop 0
    buffer_load_dwordx4 v240, s[12:15], 0 offen nt lds
    buffer_load_dwordx4 v241, s[12:15], 0 offen offset:1024 nt lds
    s_add_u32 m0, s30, 16384
    s_mov_b32 s41, 49152
    buffer_load_dwordx4 v240, s[12:15], s41 offen nt lds
    buffer_load_dwordx4 v241, s[12:15], s41 offen offset:1024 nt lds
    s_add_u32 m0, s30, 32768
    s_nop 0
    buffer_load_dwordx4 v240, s[16:19], 0 offen nt lds
    buffer_load_dwordx4 v241, s[16:19], 0 offen offset:1024 nt lds
    s_barrier
    s_add_u32 m0, s30, 49152
    s_mov_b32 s41, 128
    buffer_load_dwordx4 v240, s[12:15], s41 offen nt lds
    buffer_load_dwordx4 v241, s[12:15], s41 offen offset:1024 nt lds
    s_add_u32 m0, s30, 65536
    s_mov_b32 s41, 49280
    buffer_load_dwordx4 v240, s[12:15], s41 offen nt lds
    buffer_load_dwordx4 v241, s[12:15], s41 offen offset:1024 nt lds
    s_add_u32 m0, s30, 81920
    s_mov_b32 s41, 128
    buffer_load_dwordx4 v240, s[16:19], s41 offen nt lds
    buffer_load_dwordx4 v241, s[16:19], s41 offen offset:1024 nt lds
    s_add_u32 m0, s30, 98304
    s_mov_b32 s41, 256
    buffer_load_dwordx4 v240, s[12:15], s41 offen nt lds
    buffer_load_dwordx4 v241, s[12:15], s41 offen offset:1024 nt lds
    s_add_u32 s20, s8, s34
    s_addc_u32 s21, s9, 0
    s_and_b32 s21, s21, 0xffff
    s_mov_b32 s22, 98304
    s_mov_b32 s23, 0x20000
    s_add_u32 s24, s10, s34
    s_addc_u32 s25, s11, 0
    s_and_b32 s25, s25, 0xffff
    s_mov_b32 s26, 98304
    s_mov_b32 s27, 0x20000
    s_add_u32 s44, s12, 25165824
    s_addc_u32 s45, s13, 0
    s_and_b32 s45, s45, 0xffff
    s_mov_b32 s46, 98304
    s_mov_b32 s47, 0x20000
    s_add_u32 s48, s16, 25165824
    s_addc_u32 s49, s17, 0
    s_and_b32 s49, s49, 0xffff
    s_mov_b32 s50, 98304
    s_mov_b32 s51, 0x20000
    s_add_u32 s52, s20, 25165824
    s_addc_u32 s53, s21, 0
    s_and_b32 s53, s53, 0xffff
    s_mov_b32 s54, 98304
    s_mov_b32 s55, 0x20000
    s_add_u32 s76, s24, 25165824
    s_addc_u32 s77, s25, 0
    s_and_b32 s77, s77, 0xffff
    s_mov_b32 s78, 98304
    s_mov_b32 s79, 0x20000
    s_mov_b32 s32, 0x3dd53b95
    s_mov_b32 s42, 0xbdd53b95
    s_mov_b32 s43, 0x4299ac27
    s_mov_b32 s33, 0
    s_mov_b32 s36, 0
    s_mov_b32 s37, 3072
    s_mov_b32 s38, 6144
    s_mov_b32 s39, 9216
    s_and_b32 s31, s35, 3
    s_lshl_b32 s31, s31, 12
    s_lshr_b32 s34, s35, 2
    s_lshl_b32 s41, s34, 14
    s_add_u32 s31, s31, s41
    s_cmp_lg_u32 s34, 0
    s_cselect_b64 vcc, -1, 0
    v_and_b32 v3, 31, v2
    v_and_b32 v4, 2, v3
    v_lshlrev_b32 v4, 1, v4
    v_bfe_u32 v5, v3, 2, 2
    v_or_b32 v4, v4, v5
    v_xor_b32 v4, v4, v6
    v_lshlrev_b32 v4, 4, v4
    v_lshlrev_b32 v5, 7, v3
    v_add_u32 v245, v5, v4
    s_lshl_b32 s34, s35, 12
    s_add_u32 s34, s34, 131072
    v_and_b32 v4, 7, v3
    v_lshlrev_b32 v4, 4, v4
    v_add_u32 v5, v5, v4
    v_lshlrev_b32 v4, 3, v6
    v_add_u32 v5, v5, v4
    v_add_u32 v243, s34, v5
    v_lshrrev_b32 v5, 3, v2
    v_xor_b32 v8, v5, v7
    v_lshlrev_b32 v8, 4, v8
    v_lshlrev_b32 v4, 7, v5
    v_add_u32 v8, v8, v4
    v_add_u32 v244, s34, v8
    s_lshl_b32 s34, s35, 5
    v_add_u32 v5, s34, v5
    v_mul_lo_u32 v5, v5, s40
    v_lshlrev_b32 v4, 4, v7
    v_add_u32 v242, v5, v4
    v_bfe_u32 v5, v2, 2, 2
    v_lshlrev_b32 v4, 2, v6
    v_add_u32 v4, v4, v5
    v_lshlrev_b32 v4, 7, v4
    v_lshrrev_b32 v8, 1, v5
    v_lshlrev_b32 v8, 2, v8
    v_or_b32 v8, v8, v6
    v_bfe_u32 v9, v2, 4, 1
    v_lshlrev_b32 v9, 1, v9
    v_bfe_u32 v10, v2, 1, 1
    v_or_b32 v9, v9, v10
    v_xor_b32 v8, v8, v9
    v_lshlrev_b32 v8, 4, v8
    v_add_u32 v4, v4, v8
    v_and_b32 v9, 1, v2
    v_lshlrev_b32 v9, 3, v9
    v_add_u32 v246, v4, v9
    s_waitcnt vmcnt(4)
    s_barrier
    s_mov_b32 s40, s31
    v_add_u32 v248, s40, v245
    v_xor_b32 v249, 32, v248
    v_xor_b32 v250, 64, v248
    v_xor_b32 v251, 0x60, v248
    ds_read_b128 v[224:227], v248
    ds_read_b128 v[228:231], v249
    ds_read_b128 v[232:235], v250
    ds_read_b128 v[236:239], v251
    s_add_u32 s40, s31, 49152
    v_add_u32 v248, s40, v245
    v_xor_b32 v249, 32, v248
    v_xor_b32 v250, 64, v248
    v_xor_b32 v251, 0x60, v248
    ds_read_b128 v[128:131], v248
    ds_read_b128 v[132:135], v249
    ds_read_b128 v[136:139], v250
    ds_read_b128 v[140:143], v251
    v_add_u32 v248, 32768, v245
    v_xor_b32 v249, 32, v248
    v_xor_b32 v250, 64, v248
    v_xor_b32 v251, 0x60, v248
    s_add_u32 m0, s30, 114688
    s_mov_b32 s41, 49408
    buffer_load_dwordx4 v240, s[12:15], s41 offen nt lds
    buffer_load_dwordx4 v241, s[12:15], s41 offen offset:1024 nt lds
    s_waitcnt lgkmcnt(0)
    s_barrier
    s_mov_b32 m0, s30
    s_mov_b32 s41, 256
    buffer_load_dwordx4 v240, s[16:19], s41 offen nt lds
    buffer_load_dwordx4 v241, s[16:19], s41 offen offset:1024 nt lds
    s_add_u32 m0, s30, 16384
    s_mov_b32 s41, 49152
    buffer_load_dwordx4 v240, s[16:19], s41 offen nt lds
    buffer_load_dwordx4 v241, s[16:19], s41 offen offset:1024 nt lds
    ds_read_b128 v[192:195], v248 offset:0
    ds_read_b128 v[196:199], v249 offset:0
    ds_read_b128 v[200:203], v250 offset:0
    ds_read_b128 v[204:207], v251 offset:0
    ds_read_b128 v[208:211], v248 offset:4096
    ds_read_b128 v[212:215], v249 offset:4096
    s_waitcnt lgkmcnt(4)
    v_mfma_f32_32x32x16_bf16 v[0:15], v[192:195], v[224:227], 0
    ds_read_b128 v[216:219], v250 offset:4096
    v_mfma_f32_32x32x16_bf16 v[0:15], v[196:199], v[228:231], v[0:15]
    ds_read_b128 v[220:223], v251 offset:4096
    s_waitcnt lgkmcnt(4)
    v_mfma_f32_32x32x16_bf16 v[0:15], v[200:203], v[232:235], v[0:15]
    ds_read_b128 v[192:195], v248 offset:8192
    v_mfma_f32_32x32x16_bf16 v[0:15], v[204:207], v[236:239], v[0:15]
    ds_read_b128 v[196:199], v249 offset:8192
    s_waitcnt lgkmcnt(4)
    v_mfma_f32_32x32x16_bf16 v[16:31], v[208:211], v[224:227], 0
    ds_read_b128 v[200:203], v250 offset:8192
    v_mfma_f32_32x32x16_bf16 v[16:31], v[212:215], v[228:231], v[16:31]
    ds_read_b128 v[204:207], v251 offset:8192
    s_waitcnt lgkmcnt(4)
    v_mfma_f32_32x32x16_bf16 v[16:31], v[216:219], v[232:235], v[16:31]
    ds_read_b128 v[208:211], v248 offset:12288
    v_mfma_f32_32x32x16_bf16 v[16:31], v[220:223], v[236:239], v[16:31]
    ds_read_b128 v[212:215], v249 offset:12288
    s_waitcnt lgkmcnt(4)
    v_mfma_f32_32x32x16_bf16 v[32:47], v[192:195], v[224:227], 0
    ds_read_b128 v[216:219], v250 offset:12288
    v_mfma_f32_32x32x16_bf16 v[32:47], v[196:199], v[228:231], v[32:47]
    ds_read_b128 v[220:223], v251 offset:12288
    s_waitcnt lgkmcnt(4)
    v_mfma_f32_32x32x16_bf16 v[32:47], v[200:203], v[232:235], v[32:47]
    v_mfma_f32_32x32x16_bf16 v[32:47], v[204:207], v[236:239], v[32:47]
    s_waitcnt lgkmcnt(2)
    v_mfma_f32_32x32x16_bf16 v[48:63], v[208:211], v[224:227], 0
    v_mfma_f32_32x32x16_bf16 v[48:63], v[212:215], v[228:231], v[48:63]
    s_waitcnt lgkmcnt(0)
    s_waitcnt vmcnt(8)
    s_barrier
    v_add_u32 v248, 81920, v245
    v_xor_b32 v249, 32, v248
    v_xor_b32 v250, 64, v248
    v_xor_b32 v251, 0x60, v248
    ds_read_b128 v[192:195], v248 offset:0
    ds_read_b128 v[196:199], v249 offset:0
    s_add_u32 m0, s30, 32768
    s_mov_b32 s41, 49280
    buffer_load_dwordx4 v240, s[16:19], s41 offen nt lds
    buffer_load_dwordx4 v241, s[16:19], s41 offen offset:1024 nt lds
    v_mfma_f32_32x32x16_bf16 v[48:63], v[216:219], v[232:235], v[48:63]
    ds_read_b128 v[200:203], v250 offset:0
    ds_read_b128 v[204:207], v251 offset:0
    s_add_u32 m0, s30, 49152
    s_mov_b32 s41, 49408
    buffer_load_dwordx4 v240, s[16:19], s41 offen nt lds
    buffer_load_dwordx4 v241, s[16:19], s41 offen offset:1024 nt lds
    v_mfma_f32_32x32x16_bf16 v[48:63], v[220:223], v[236:239], v[48:63]
    ds_read_b128 v[208:211], v248 offset:4096
    ds_read_b128 v[212:215], v249 offset:4096
    s_add_u32 m0, s30, 65536
    s_nop 0
    buffer_load_dwordx4 v240, s[20:23], 0 offen nt lds
    buffer_load_dwordx4 v241, s[20:23], 0 offen offset:1024 nt lds
    s_waitcnt lgkmcnt(4)
    v_mfma_f32_32x32x16_bf16 v[0:15], v[192:195], v[128:131], v[0:15]
    ds_read_b128 v[216:219], v250 offset:4096
    v_mfma_f32_32x32x16_bf16 v[0:15], v[196:199], v[132:135], v[0:15]
    ds_read_b128 v[220:223], v251 offset:4096
    s_waitcnt lgkmcnt(4)
    v_mfma_f32_32x32x16_bf16 v[0:15], v[200:203], v[136:139], v[0:15]
    ds_read_b128 v[192:195], v248 offset:8192
    v_mfma_f32_32x32x16_bf16 v[0:15], v[204:207], v[140:143], v[0:15]
    ds_read_b128 v[196:199], v249 offset:8192
    s_waitcnt lgkmcnt(4)
    v_mfma_f32_32x32x16_bf16 v[16:31], v[208:211], v[128:131], v[16:31]
    ds_read_b128 v[200:203], v250 offset:8192
    v_mfma_f32_32x32x16_bf16 v[16:31], v[212:215], v[132:135], v[16:31]
    ds_read_b128 v[204:207], v251 offset:8192
    s_waitcnt lgkmcnt(4)
    v_mfma_f32_32x32x16_bf16 v[16:31], v[216:219], v[136:139], v[16:31]
    ds_read_b128 v[208:211], v248 offset:12288
    v_mfma_f32_32x32x16_bf16 v[16:31], v[220:223], v[140:143], v[16:31]
    ds_read_b128 v[212:215], v249 offset:12288
    s_waitcnt lgkmcnt(4)
    v_mfma_f32_32x32x16_bf16 v[32:47], v[192:195], v[128:131], v[32:47]
    ds_read_b128 v[216:219], v250 offset:12288
    v_mfma_f32_32x32x16_bf16 v[32:47], v[196:199], v[132:135], v[32:47]
    ds_read_b128 v[220:223], v251 offset:12288
    s_waitcnt lgkmcnt(4)
    v_mfma_f32_32x32x16_bf16 v[32:47], v[200:203], v[136:139], v[32:47]
    v_mfma_f32_32x32x16_bf16 v[32:47], v[204:207], v[140:143], v[32:47]
    s_waitcnt lgkmcnt(2)
    v_mfma_f32_32x32x16_bf16 v[48:63], v[208:211], v[128:131], v[48:63]
    v_mfma_f32_32x32x16_bf16 v[48:63], v[212:215], v[132:135], v[48:63]
    s_waitcnt lgkmcnt(0)
    s_waitcnt vmcnt(8)
    s_barrier
    s_add_u32 s40, s31, 98304
    v_add_u32 v248, s40, v245
    v_xor_b32 v249, 32, v248
    v_xor_b32 v250, 64, v248
    v_xor_b32 v251, 0x60, v248
    ds_read_b128 v[144:147], v248
    ds_read_b128 v[148:151], v249
    ds_read_b128 v[152:155], v250
    ds_read_b128 v[156:159], v251
    v_mov_b32 v248, v245
    v_xor_b32 v249, 32, v248
    v_xor_b32 v250, 64, v248
    v_xor_b32 v251, 0x60, v248
    ds_read_b128 v[192:195], v248 offset:0
    ds_read_b128 v[196:199], v249 offset:0
    s_add_u32 m0, s30, 81920
    s_mov_b32 s41, 128
    buffer_load_dwordx4 v240, s[20:23], s41 offen nt lds
    buffer_load_dwordx4 v241, s[20:23], s41 offen offset:1024 nt lds
    v_mfma_f32_32x32x16_bf16 v[48:63], v[216:219], v[136:139], v[48:63]
    ds_read_b128 v[200:203], v250 offset:0
    ds_read_b128 v[204:207], v251 offset:0
    v_mfma_f32_32x32x16_bf16 v[48:63], v[220:223], v[140:143], v[48:63]
    ds_read_b128 v[208:211], v248 offset:4096
    ds_read_b128 v[212:215], v249 offset:4096
    s_waitcnt lgkmcnt(4)
    v_mfma_f32_32x32x16_bf16 v[0:15], v[192:195], v[144:147], v[0:15]
    ds_read_b128 v[216:219], v250 offset:4096
    v_mfma_f32_32x32x16_bf16 v[0:15], v[196:199], v[148:151], v[0:15]
    ds_read_b128 v[220:223], v251 offset:4096
    s_waitcnt lgkmcnt(4)
    v_mfma_f32_32x32x16_bf16 v[0:15], v[200:203], v[152:155], v[0:15]
    ds_read_b128 v[192:195], v248 offset:8192
    v_mfma_f32_32x32x16_bf16 v[0:15], v[204:207], v[156:159], v[0:15]
    ds_read_b128 v[196:199], v249 offset:8192
    s_waitcnt lgkmcnt(4)
    v_mfma_f32_32x32x16_bf16 v[16:31], v[208:211], v[144:147], v[16:31]
    ds_read_b128 v[200:203], v250 offset:8192
    v_mfma_f32_32x32x16_bf16 v[16:31], v[212:215], v[148:151], v[16:31]
    ds_read_b128 v[204:207], v251 offset:8192
    s_waitcnt lgkmcnt(4)
    v_mfma_f32_32x32x16_bf16 v[16:31], v[216:219], v[152:155], v[16:31]
    ds_read_b128 v[208:211], v248 offset:12288
    v_mfma_f32_32x32x16_bf16 v[16:31], v[220:223], v[156:159], v[16:31]
    ds_read_b128 v[212:215], v249 offset:12288
    s_waitcnt lgkmcnt(4)
    v_mfma_f32_32x32x16_bf16 v[32:47], v[192:195], v[144:147], v[32:47]
    ds_read_b128 v[216:219], v250 offset:12288
    v_max3_f32 v176, v0, v1, v2
    v_max3_f32 v177, v3, v4, v5
    v_max3_f32 v178, v6, v7, v8
    v_max3_f32 v179, v9, v10, v11
    v_max3_f32 v176, v176, v12, v13
    v_max3_f32 v177, v177, v14, v15
    v_mfma_f32_32x32x16_bf16 v[32:47], v[196:199], v[148:151], v[32:47]
    ds_read_b128 v[220:223], v251 offset:12288
    s_waitcnt lgkmcnt(4)
    v_mfma_f32_32x32x16_bf16 v[32:47], v[200:203], v[152:155], v[32:47]
    v_mfma_f32_32x32x16_bf16 v[32:47], v[204:207], v[156:159], v[32:47]
    s_waitcnt lgkmcnt(2)
    v_mfma_f32_32x32x16_bf16 v[48:63], v[208:211], v[144:147], v[48:63]
    v_max3_f32 v178, v178, v16, v17
    v_max3_f32 v179, v179, v18, v19
    v_max3_f32 v176, v176, v20, v21
    v_max3_f32 v177, v177, v22, v23
    v_max3_f32 v178, v178, v24, v25
    v_max3_f32 v179, v179, v26, v27
    v_max3_f32 v176, v176, v28, v29
    v_max3_f32 v177, v177, v30, v31
    v_mfma_f32_32x32x16_bf16 v[48:63], v[212:215], v[148:151], v[48:63]
    s_waitcnt lgkmcnt(0)
    s_waitcnt vmcnt(8)
    s_barrier
    v_add_u32 v248, 16384, v245
    v_xor_b32 v249, 32, v248
    v_xor_b32 v250, 64, v248
    v_xor_b32 v251, 0x60, v248
    ds_read_b128 v[192:195], v248 offset:0
    ds_read_b128 v[196:199], v249 offset:0
    s_add_u32 m0, s30, 98304
    s_mov_b32 s41, 256
    buffer_load_dwordx4 v240, s[20:23], s41 offen nt lds
    buffer_load_dwordx4 v241, s[20:23], s41 offen offset:1024 nt lds
    v_mfma_f32_32x32x16_bf16 v[48:63], v[216:219], v[152:155], v[48:63]
    ds_read_b128 v[200:203], v250 offset:0
    ds_read_b128 v[204:207], v251 offset:0
    s_add_u32 m0, s30, 114688
    s_mov_b32 s41, 49152
    buffer_load_dwordx4 v240, s[20:23], s41 offen nt lds
    buffer_load_dwordx4 v241, s[20:23], s41 offen offset:1024 nt lds
    v_mfma_f32_32x32x16_bf16 v[48:63], v[220:223], v[156:159], v[48:63]
    ds_read_b128 v[208:211], v248 offset:4096
    ds_read_b128 v[212:215], v249 offset:4096
    s_mov_b32 m0, s30
    s_mov_b32 s41, 49280
    buffer_load_dwordx4 v240, s[20:23], s41 offen nt lds
    buffer_load_dwordx4 v241, s[20:23], s41 offen offset:1024 nt lds
    s_waitcnt lgkmcnt(4)
    v_mfma_f32_32x32x16_bf16 v[64:79], v[192:195], v[224:227], 0
    ds_read_b128 v[216:219], v250 offset:4096
    v_max3_f32 v178, v178, v32, v33
    v_max3_f32 v179, v179, v34, v35
    v_max3_f32 v176, v176, v36, v37
    v_max3_f32 v177, v177, v38, v39
    v_max3_f32 v178, v178, v40, v41
    v_max3_f32 v179, v179, v42, v43
    v_max3_f32 v176, v176, v44, v45
    v_max3_f32 v177, v177, v46, v47
    v_mfma_f32_32x32x16_bf16 v[64:79], v[196:199], v[228:231], v[64:79]
    ds_read_b128 v[220:223], v251 offset:4096
    s_waitcnt lgkmcnt(4)
    v_mfma_f32_32x32x16_bf16 v[64:79], v[200:203], v[232:235], v[64:79]
    ds_read_b128 v[192:195], v248 offset:8192
    v_mfma_f32_32x32x16_bf16 v[64:79], v[204:207], v[236:239], v[64:79]
    ds_read_b128 v[196:199], v249 offset:8192
    s_waitcnt lgkmcnt(4)
    v_mfma_f32_32x32x16_bf16 v[80:95], v[208:211], v[224:227], 0
    ds_read_b128 v[200:203], v250 offset:8192
    v_max3_f32 v178, v178, v48, v49
    v_max3_f32 v179, v179, v50, v51
    v_max3_f32 v176, v176, v52, v53
    v_max3_f32 v177, v177, v54, v55
    v_max3_f32 v178, v178, v56, v57
    v_max3_f32 v179, v179, v58, v59
    v_max3_f32 v176, v176, v60, v61
    v_max3_f32 v177, v177, v62, v63
    v_max3_f32 v176, v176, v177, v178
    v_max_f32 v180, v176, v179
    v_max_f32 v181, v176, v179
    v_mov_b32 v182, 0
    v_mov_b32 v183, 0
    v_mov_b32 v184, 0
    v_mov_b32 v185, 0
    v_permlane32_swap_b32 v180, v181
    s_nop 0
    v_max_f32 v252, v180, v181
    v_mul_f32 v254, s42, v252
    v_fma_f32 v0, v0, s32, v254
    v_fma_f32 v1, v1, s32, v254
    v_fma_f32 v2, v2, s32, v254
    v_fma_f32 v3, v3, s32, v254
    v_exp_f32 v0, v0
    v_exp_f32 v1, v1
    v_fma_f32 v4, v4, s32, v254
    v_fma_f32 v5, v5, s32, v254
    v_exp_f32 v2, v2
    v_exp_f32 v3, v3
    v_add_f32 v182, v182, v0
    v_add_f32 v183, v183, v1
    v_cvt_pk_bf16_f32 v0, v0, v1
    v_fma_f32 v6, v6, s32, v254
    v_fma_f32 v7, v7, s32, v254
    v_exp_f32 v4, v4
    v_exp_f32 v5, v5
    v_add_f32 v184, v184, v2
    v_add_f32 v185, v185, v3
    v_cvt_pk_bf16_f32 v1, v2, v3
    v_fma_f32 v8, v8, s32, v254
    v_fma_f32 v9, v9, s32, v254
    v_exp_f32 v6, v6
    v_exp_f32 v7, v7
    v_add_f32 v182, v182, v4
    v_add_f32 v183, v183, v5
    v_cvt_pk_bf16_f32 v2, v4, v5
    v_fma_f32 v10, v10, s32, v254
    v_fma_f32 v11, v11, s32, v254
    v_exp_f32 v8, v8
    v_exp_f32 v9, v9
    v_add_f32 v184, v184, v6
    v_add_f32 v185, v185, v7
    v_cvt_pk_bf16_f32 v3, v6, v7
    v_mfma_f32_32x32x16_bf16 v[80:95], v[212:215], v[228:231], v[80:95]
    ds_read_b128 v[204:207], v251 offset:8192
    v_fma_f32 v12, v12, s32, v254
    v_fma_f32 v13, v13, s32, v254
    v_exp_f32 v10, v10
    v_exp_f32 v11, v11
    s_waitcnt lgkmcnt(4)
    v_mfma_f32_32x32x16_bf16 v[80:95], v[216:219], v[232:235], v[80:95]
    ds_read_b128 v[208:211], v248 offset:12288
    v_add_f32 v182, v182, v8
    v_add_f32 v183, v183, v9
    v_cvt_pk_bf16_f32 v4, v8, v9
    v_fma_f32 v14, v14, s32, v254
    v_fma_f32 v15, v15, s32, v254
    v_mfma_f32_32x32x16_bf16 v[80:95], v[220:223], v[236:239], v[80:95]
    ds_read_b128 v[212:215], v249 offset:12288
    v_exp_f32 v12, v12
    v_exp_f32 v13, v13
    v_add_f32 v184, v184, v10
    v_add_f32 v185, v185, v11
    s_waitcnt lgkmcnt(4)
    v_mfma_f32_32x32x16_bf16 v[96:111], v[192:195], v[224:227], 0
    ds_read_b128 v[216:219], v250 offset:12288
    v_cvt_pk_bf16_f32 v5, v10, v11
    v_fma_f32 v16, v16, s32, v254
    v_fma_f32 v17, v17, s32, v254
    v_exp_f32 v14, v14
    v_exp_f32 v15, v15
    v_mfma_f32_32x32x16_bf16 v[96:111], v[196:199], v[228:231], v[96:111]
    ds_read_b128 v[220:223], v251 offset:12288
    v_add_f32 v182, v182, v12
    v_add_f32 v183, v183, v13
    v_cvt_pk_bf16_f32 v6, v12, v13
    v_fma_f32 v18, v18, s32, v254
    s_waitcnt lgkmcnt(4)
    v_mfma_f32_32x32x16_bf16 v[96:111], v[200:203], v[232:235], v[96:111]
    v_fma_f32 v19, v19, s32, v254
    v_exp_f32 v16, v16
    v_exp_f32 v17, v17
    v_add_f32 v184, v184, v14
    v_mfma_f32_32x32x16_bf16 v[96:111], v[204:207], v[236:239], v[96:111]
    v_add_f32 v185, v185, v15
    v_cvt_pk_bf16_f32 v7, v14, v15
    v_fma_f32 v20, v20, s32, v254
    v_fma_f32 v21, v21, s32, v254
    v_exp_f32 v18, v18
    s_waitcnt lgkmcnt(2)
    v_mfma_f32_32x32x16_bf16 v[112:127], v[208:211], v[224:227], 0
    v_exp_f32 v19, v19
    v_add_f32 v182, v182, v16
    v_add_f32 v183, v183, v17
    v_cvt_pk_bf16_f32 v8, v16, v17
    v_mfma_f32_32x32x16_bf16 v[112:127], v[212:215], v[228:231], v[112:127]
    s_waitcnt lgkmcnt(0)
    s_waitcnt vmcnt(12)
    s_barrier
    v_add_u32 v248, 32768, v245
    v_xor_b32 v249, 32, v248
    v_xor_b32 v250, 64, v248
    v_xor_b32 v251, 0x60, v248
    ds_read_b128 v[192:195], v248 offset:0
    v_fma_f32 v22, v22, s32, v254
    v_fma_f32 v23, v23, s32, v254
    ds_read_b128 v[196:199], v249 offset:0
    s_add_u32 m0, s30, 16384
    s_mov_b32 s41, 49408
    buffer_load_dwordx4 v240, s[20:23], s41 offen nt lds
    buffer_load_dwordx4 v241, s[20:23], s41 offen offset:1024 nt lds
    v_exp_f32 v20, v20
    v_exp_f32 v21, v21
    v_mfma_f32_32x32x16_bf16 v[112:127], v[216:219], v[232:235], v[112:127]
    ds_read_b128 v[200:203], v250 offset:0
    v_add_f32 v184, v184, v18
    v_add_f32 v185, v185, v19
    ds_read_b128 v[204:207], v251 offset:0
    v_cvt_pk_bf16_f32 v9, v18, v19
    v_fma_f32 v24, v24, s32, v254
    v_fma_f32 v25, v25, s32, v254
    v_mfma_f32_32x32x16_bf16 v[112:127], v[220:223], v[236:239], v[112:127]
    ds_read_b128 v[208:211], v248 offset:4096
    v_exp_f32 v22, v22
    v_exp_f32 v23, v23
    ds_read_b128 v[212:215], v249 offset:4096
    v_add_f32 v182, v182, v20
    v_add_f32 v183, v183, v21
    s_waitcnt lgkmcnt(4)
    v_mfma_f32_32x32x16_bf16 v[64:79], v[192:195], v[128:131], v[64:79]
    ds_read_b128 v[216:219], v250 offset:4096
    v_cvt_pk_bf16_f32 v10, v20, v21
    v_fma_f32 v26, v26, s32, v254
    v_fma_f32 v27, v27, s32, v254
    v_exp_f32 v24, v24
    v_exp_f32 v25, v25
    v_mfma_f32_32x32x16_bf16 v[64:79], v[196:199], v[132:135], v[64:79]
    ds_read_b128 v[220:223], v251 offset:4096
    v_add_f32 v184, v184, v22
    v_add_f32 v185, v185, v23
    v_cvt_pk_bf16_f32 v11, v22, v23
    v_fma_f32 v28, v28, s32, v254
    s_waitcnt lgkmcnt(4)
    v_mfma_f32_32x32x16_bf16 v[64:79], v[200:203], v[136:139], v[64:79]
    ds_read_b128 v[192:195], v248 offset:8192
    v_fma_f32 v29, v29, s32, v254
    v_exp_f32 v26, v26
    v_exp_f32 v27, v27
    v_add_f32 v182, v182, v24
    v_mfma_f32_32x32x16_bf16 v[64:79], v[204:207], v[140:143], v[64:79]
    ds_read_b128 v[196:199], v249 offset:8192
    v_add_f32 v183, v183, v25
    v_cvt_pk_bf16_f32 v12, v24, v25
    v_fma_f32 v30, v30, s32, v254
    v_fma_f32 v31, v31, s32, v254
    v_exp_f32 v28, v28
    s_waitcnt lgkmcnt(4)
    v_mfma_f32_32x32x16_bf16 v[80:95], v[208:211], v[128:131], v[80:95]
    ds_read_b128 v[200:203], v250 offset:8192
    v_exp_f32 v29, v29
    v_add_f32 v184, v184, v26
    v_add_f32 v185, v185, v27
    v_cvt_pk_bf16_f32 v13, v26, v27
    v_mfma_f32_32x32x16_bf16 v[80:95], v[212:215], v[132:135], v[80:95]
    ds_read_b128 v[204:207], v251 offset:8192
    v_fma_f32 v32, v32, s32, v254
    v_fma_f32 v33, v33, s32, v254
    v_exp_f32 v30, v30
    v_exp_f32 v31, v31
    s_waitcnt lgkmcnt(4)
    v_mfma_f32_32x32x16_bf16 v[80:95], v[216:219], v[136:139], v[80:95]
    ds_read_b128 v[208:211], v248 offset:12288
    v_add_f32 v182, v182, v28
    v_add_f32 v183, v183, v29
    v_cvt_pk_bf16_f32 v14, v28, v29
    v_fma_f32 v34, v34, s32, v254
    v_fma_f32 v35, v35, s32, v254
    v_mfma_f32_32x32x16_bf16 v[80:95], v[220:223], v[140:143], v[80:95]
    ds_read_b128 v[212:215], v249 offset:12288
    v_exp_f32 v32, v32
    v_exp_f32 v33, v33
    v_add_f32 v184, v184, v30
    v_add_f32 v185, v185, v31
    s_waitcnt lgkmcnt(4)
    v_mfma_f32_32x32x16_bf16 v[96:111], v[192:195], v[128:131], v[96:111]
    ds_read_b128 v[216:219], v250 offset:12288
    v_cvt_pk_bf16_f32 v15, v30, v31
    v_fma_f32 v36, v36, s32, v254
    v_fma_f32 v37, v37, s32, v254
    v_exp_f32 v34, v34
    v_exp_f32 v35, v35
    v_mfma_f32_32x32x16_bf16 v[96:111], v[196:199], v[132:135], v[96:111]
    ds_read_b128 v[220:223], v251 offset:12288
    v_add_f32 v182, v182, v32
    v_add_f32 v183, v183, v33
    v_cvt_pk_bf16_f32 v16, v32, v33
    v_fma_f32 v38, v38, s32, v254
    s_waitcnt lgkmcnt(4)
    v_mfma_f32_32x32x16_bf16 v[96:111], v[200:203], v[136:139], v[96:111]
    v_fma_f32 v39, v39, s32, v254
    v_exp_f32 v36, v36
    v_exp_f32 v37, v37
    v_add_f32 v184, v184, v34
    v_mfma_f32_32x32x16_bf16 v[96:111], v[204:207], v[140:143], v[96:111]
    v_add_f32 v185, v185, v35
    v_cvt_pk_bf16_f32 v17, v34, v35
    v_fma_f32 v40, v40, s32, v254
    v_fma_f32 v41, v41, s32, v254
    v_exp_f32 v38, v38
    s_waitcnt lgkmcnt(2)
    v_mfma_f32_32x32x16_bf16 v[112:127], v[208:211], v[128:131], v[112:127]
    v_exp_f32 v39, v39
    v_add_f32 v182, v182, v36
    v_add_f32 v183, v183, v37
    v_cvt_pk_bf16_f32 v18, v36, v37
    v_mfma_f32_32x32x16_bf16 v[112:127], v[212:215], v[132:135], v[112:127]
    s_waitcnt lgkmcnt(0)
    s_waitcnt vmcnt(12)
    s_barrier
    v_add_u32 v248, 49152, v245
    v_xor_b32 v249, 32, v248
    v_xor_b32 v250, 64, v248
    v_xor_b32 v251, 0x60, v248
    ds_read_b128 v[192:195], v248 offset:0
    v_fma_f32 v42, v42, s32, v254
    v_fma_f32 v43, v43, s32, v254
    ds_read_b128 v[196:199], v249 offset:0
    s_add_u32 m0, s30, 32768
    s_nop 0
    buffer_load_dwordx4 v240, s[44:47], 0 offen nt lds
    buffer_load_dwordx4 v241, s[44:47], 0 offen offset:1024 nt lds
    v_exp_f32 v40, v40
    v_exp_f32 v41, v41
    v_mfma_f32_32x32x16_bf16 v[112:127], v[216:219], v[136:139], v[112:127]
    ds_read_b128 v[200:203], v250 offset:0
    v_add_f32 v184, v184, v38
    v_add_f32 v185, v185, v39
    v_cvt_pk_bf16_f32 v19, v38, v39
    ds_read_b128 v[204:207], v251 offset:0
    v_fma_f32 v44, v44, s32, v254
    v_fma_f32 v45, v45, s32, v254
    v_exp_f32 v42, v42
    v_mfma_f32_32x32x16_bf16 v[112:127], v[220:223], v[140:143], v[112:127]
    ds_read_b128 v[208:211], v248 offset:4096
    v_exp_f32 v43, v43
    ds_read_b128 v[212:215], v249 offset:4096
    v_add_f32 v182, v182, v40
    v_add_f32 v183, v183, v41
    s_waitcnt lgkmcnt(4)
    v_mfma_f32_32x32x16_bf16 v[64:79], v[192:195], v[144:147], v[64:79]
    ds_read_b128 v[216:219], v250 offset:4096
    v_cvt_pk_bf16_f32 v20, v40, v41
    v_fma_f32 v46, v46, s32, v254
    v_fma_f32 v47, v47, s32, v254
    v_exp_f32 v44, v44
    v_exp_f32 v45, v45
    v_mfma_f32_32x32x16_bf16 v[64:79], v[196:199], v[148:151], v[64:79]
    ds_read_b128 v[220:223], v251 offset:4096
    v_add_f32 v184, v184, v42
    v_add_f32 v185, v185, v43
    v_cvt_pk_bf16_f32 v21, v42, v43
    v_fma_f32 v48, v48, s32, v254
    s_waitcnt lgkmcnt(4)
    v_mfma_f32_32x32x16_bf16 v[64:79], v[200:203], v[152:155], v[64:79]
    ds_read_b128 v[192:195], v248 offset:8192
    v_fma_f32 v49, v49, s32, v254
    v_exp_f32 v46, v46
    v_exp_f32 v47, v47
    v_add_f32 v182, v182, v44
    v_mfma_f32_32x32x16_bf16 v[64:79], v[204:207], v[156:159], v[64:79]
    ds_read_b128 v[196:199], v249 offset:8192
    v_add_f32 v183, v183, v45
    v_cvt_pk_bf16_f32 v22, v44, v45
    v_fma_f32 v50, v50, s32, v254
    v_fma_f32 v51, v51, s32, v254
    v_exp_f32 v48, v48
    s_waitcnt lgkmcnt(4)
    v_mfma_f32_32x32x16_bf16 v[80:95], v[208:211], v[144:147], v[80:95]
    ds_read_b128 v[200:203], v250 offset:8192
    v_exp_f32 v49, v49
    v_add_f32 v184, v184, v46
    v_add_f32 v185, v185, v47
    v_cvt_pk_bf16_f32 v23, v46, v47
    v_mfma_f32_32x32x16_bf16 v[80:95], v[212:215], v[148:151], v[80:95]
    ds_read_b128 v[204:207], v251 offset:8192
    v_fma_f32 v52, v52, s32, v254
    v_fma_f32 v53, v53, s32, v254
    v_exp_f32 v50, v50
    v_exp_f32 v51, v51
    s_waitcnt lgkmcnt(4)
    v_mfma_f32_32x32x16_bf16 v[80:95], v[216:219], v[152:155], v[80:95]
    ds_read_b128 v[208:211], v248 offset:12288
    v_add_f32 v182, v182, v48
    v_add_f32 v183, v183, v49
    v_cvt_pk_bf16_f32 v24, v48, v49
    v_fma_f32 v54, v54, s32, v254
    v_fma_f32 v55, v55, s32, v254
    v_exp_f32 v52, v52
    v_mfma_f32_32x32x16_bf16 v[80:95], v[220:223], v[156:159], v[80:95]
    ds_read_b128 v[212:215], v249 offset:12288
    v_exp_f32 v53, v53
    v_add_f32 v184, v184, v50
    v_add_f32 v185, v185, v51
    s_waitcnt lgkmcnt(4)
    v_mfma_f32_32x32x16_bf16 v[96:111], v[192:195], v[144:147], v[96:111]
    ds_read_b128 v[216:219], v250 offset:12288
    v_cvt_pk_bf16_f32 v25, v50, v51
    v_fma_f32 v56, v56, s32, v254
    v_fma_f32 v57, v57, s32, v254
    v_exp_f32 v54, v54
    v_exp_f32 v55, v55
    v_mfma_f32_32x32x16_bf16 v[96:111], v[196:199], v[148:151], v[96:111]
    ds_read_b128 v[220:223], v251 offset:12288
    v_add_f32 v182, v182, v52
    v_add_f32 v183, v183, v53
    v_cvt_pk_bf16_f32 v26, v52, v53
    v_fma_f32 v58, v58, s32, v254
    v_fma_f32 v59, v59, s32, v254
    s_waitcnt lgkmcnt(4)
    v_mfma_f32_32x32x16_bf16 v[96:111], v[200:203], v[152:155], v[96:111]
    v_exp_f32 v56, v56
    v_exp_f32 v57, v57
    v_add_f32 v184, v184, v54
    v_mfma_f32_32x32x16_bf16 v[96:111], v[204:207], v[156:159], v[96:111]
    v_add_f32 v185, v185, v55
    v_cvt_pk_bf16_f32 v27, v54, v55
    v_fma_f32 v60, v60, s32, v254
    v_fma_f32 v61, v61, s32, v254
    v_exp_f32 v58, v58
    s_waitcnt lgkmcnt(2)
    v_mfma_f32_32x32x16_bf16 v[112:127], v[208:211], v[144:147], v[112:127]
    v_exp_f32 v59, v59
    v_add_f32 v182, v182, v56
    v_add_f32 v183, v183, v57
    v_cvt_pk_bf16_f32 v28, v56, v57
    v_mfma_f32_32x32x16_bf16 v[112:127], v[212:215], v[148:151], v[112:127]
    s_waitcnt lgkmcnt(0)
    s_waitcnt vmcnt(12)
    s_barrier
    v_add_u32 v248, 65536, v246
    v_xor_b32 v249, 32, v248
    v_xor_b32 v250, 64, v248
    v_xor_b32 v251, 0x60, v248
    ds_read_b64_tr_b16 v[192:193], v248 offset:0
    v_fma_f32 v62, v62, s32, v254
    ds_read_b64_tr_b16 v[194:195], v249 offset:1024
    v_fma_f32 v63, v63, s32, v254
    ds_read_b64_tr_b16 v[196:197], v250 offset:0
    s_add_u32 m0, s30, 49152
    s_mov_b32 s41, 49152
    buffer_load_dwordx4 v240, s[44:47], s41 offen nt lds
    buffer_load_dwordx4 v241, s[44:47], s41 offen offset:1024 nt lds
    ds_read_b64_tr_b16 v[198:199], v251 offset:1024
    v_exp_f32 v60, v60
    v_exp_f32 v61, v61
    v_mfma_f32_32x32x16_bf16 v[112:127], v[216:219], v[152:155], v[112:127]
    ds_read_b64_tr_b16 v[200:201], v248 offset:2048
    v_add_f32 v184, v184, v58
    ds_read_b64_tr_b16 v[202:203], v249 offset:3072
    v_add_f32 v185, v185, v59
    ds_read_b64_tr_b16 v[204:205], v250 offset:2048
    v_cvt_pk_bf16_f32 v29, v58, v59
    ds_read_b64_tr_b16 v[206:207], v251 offset:3072
    v_exp_f32 v62, v62
    v_exp_f32 v63, v63
    v_mfma_f32_32x32x16_bf16 v[112:127], v[220:223], v[156:159], v[112:127]
    ds_read_b64_tr_b16 v[208:209], v248 offset:4096
    v_add_f32 v182, v182, v60
    ds_read_b64_tr_b16 v[210:211], v249 offset:5120
    v_add_f32 v183, v183, v61
    ds_read_b64_tr_b16 v[212:213], v250 offset:4096
    v_cvt_pk_bf16_f32 v30, v60, v61
    ds_read_b64_tr_b16 v[214:215], v251 offset:5120
    s_nop 0
    v_add_f32 v184, v184, v62
    s_waitcnt lgkmcnt(8)
    v_mfma_f32_32x32x16_bf16 v[128:143], v[192:195], v[0:3], 0
    ds_read_b64_tr_b16 v[216:217], v248 offset:6144
    v_add_f32 v185, v185, v63
    v_cvt_pk_bf16_f32 v31, v62, v63
    ds_read_b64_tr_b16 v[218:219], v249 offset:7168
    v_add_f32 v182, v182, v184
    v_add_f32 v183, v183, v185
    v_add_f32 v247, v182, v183
    v_mfma_f32_32x32x16_bf16 v[144:159], v[196:199], v[0:3], 0
    ds_read_b64_tr_b16 v[220:221], v250 offset:6144
    v_max3_f32 v224, v64, v65, v66
    v_max3_f32 v225, v67, v68, v69
    v_max3_f32 v226, v70, v71, v72
    ds_read_b64_tr_b16 v[222:223], v251 offset:7168
    v_max3_f32 v227, v73, v74, v75
    v_max3_f32 v224, v224, v76, v77
    v_max3_f32 v225, v225, v78, v79
    v_max3_f32 v226, v226, v80, v81
    s_waitcnt lgkmcnt(8)
    v_mfma_f32_32x32x16_bf16 v[128:143], v[200:203], v[4:7], v[128:143]
    ds_read_b64_tr_b16 v[192:193], v248 offset:8192
    v_max3_f32 v227, v227, v82, v83
    v_max3_f32 v224, v224, v84, v85
    v_max3_f32 v225, v225, v86, v87
    ds_read_b64_tr_b16 v[194:195], v249 offset:9216
    v_max3_f32 v226, v226, v88, v89
    v_max3_f32 v227, v227, v90, v91
    v_max3_f32 v224, v224, v92, v93
    v_max3_f32 v225, v225, v94, v95
    v_mfma_f32_32x32x16_bf16 v[144:159], v[204:207], v[4:7], v[144:159]
    ds_read_b64_tr_b16 v[196:197], v250 offset:8192
    v_max3_f32 v226, v226, v96, v97
    v_max3_f32 v227, v227, v98, v99
    v_max3_f32 v224, v224, v100, v101
    ds_read_b64_tr_b16 v[198:199], v251 offset:9216
    v_max3_f32 v225, v225, v102, v103
    v_max3_f32 v226, v226, v104, v105
    v_max3_f32 v227, v227, v106, v107
    s_waitcnt lgkmcnt(8)
    v_mfma_f32_32x32x16_bf16 v[128:143], v[208:211], v[8:11], v[128:143]
    ds_read_b64_tr_b16 v[200:201], v248 offset:10240
    v_max3_f32 v224, v224, v108, v109
    v_max3_f32 v225, v225, v110, v111
    v_max3_f32 v226, v226, v112, v113
    ds_read_b64_tr_b16 v[202:203], v249 offset:11264
    v_max3_f32 v227, v227, v114, v115
    v_max3_f32 v224, v224, v116, v117
    v_max3_f32 v225, v225, v118, v119
    v_max3_f32 v226, v226, v120, v121
    v_mfma_f32_32x32x16_bf16 v[144:159], v[212:215], v[8:11], v[144:159]
    ds_read_b64_tr_b16 v[204:205], v250 offset:10240
    v_max3_f32 v227, v227, v122, v123
    v_max3_f32 v224, v224, v124, v125
    v_max3_f32 v225, v225, v126, v127
    ds_read_b64_tr_b16 v[206:207], v251 offset:11264
    v_max3_f32 v224, v224, v225, v226
    v_max_f32 v228, v224, v227
    v_max_f32 v229, v224, v227
    v_mov_b32 v230, 0
    s_waitcnt lgkmcnt(8)
    v_mfma_f32_32x32x16_bf16 v[128:143], v[216:219], v[12:15], v[128:143]
    ds_read_b64_tr_b16 v[208:209], v248 offset:12288
    v_mov_b32 v231, 0
    v_mov_b32 v232, 0
    v_mov_b32 v233, 0
    ds_read_b64_tr_b16 v[210:211], v249 offset:13312
    v_permlane32_swap_b32 v228, v229
    s_nop 0
    v_max3_f32 v228, v228, v229, v252
    v_sub_f32 v229, v228, v252
    v_mfma_f32_32x32x16_bf16 v[144:159], v[220:223], v[12:15], v[144:159]
    ds_read_b64_tr_b16 v[212:213], v250 offset:12288
    v_cmp_lt_f32 s[80:81], s43, v229
    s_nop 3
    s_cmp_lg_u64 s[80:81], 0
    s_cselect_b32 s33, 1, 0
    s_cselect_b64 s[80:81], -1, 0
    s_nop 1
    v_cndmask_b32 v228, v252, v228, s[80:81]
    ds_read_b64_tr_b16 v[214:215], v251 offset:13312
    v_mul_f32 v254, s42, v228
    v_fma_f32 v229, v252, s32, v254
    s_waitcnt lgkmcnt(8)
    v_mfma_f32_32x32x16_bf16 v[128:143], v[192:195], v[16:19], v[128:143]
    ds_read_b64_tr_b16 v[216:217], v248 offset:14336
    v_exp_f32 v252, v229
    v_fma_f32 v112, v112, s32, v254
    ds_read_b64_tr_b16 v[218:219], v249 offset:15360
    v_fma_f32 v113, v113, s32, v254
    v_fma_f32 v114, v114, s32, v254
    v_fma_f32 v115, v115, s32, v254
    v_mfma_f32_32x32x16_bf16 v[144:159], v[196:199], v[16:19], v[144:159]
    ds_read_b64_tr_b16 v[220:221], v250 offset:14336
    v_exp_f32 v112, v112
    v_exp_f32 v113, v113
    ds_read_b64_tr_b16 v[222:223], v251 offset:15360
    v_fma_f32 v116, v116, s32, v254
    v_fma_f32 v117, v117, s32, v254
    v_exp_f32 v114, v114
    s_waitcnt lgkmcnt(8)
    v_mfma_f32_32x32x16_bf16 v[128:143], v[200:203], v[20:23], v[128:143]
    v_exp_f32 v115, v115
    v_add_f32 v230, v230, v112
    v_add_f32 v231, v231, v113
    v_cvt_pk_bf16_f32 v56, v112, v113
    v_fma_f32 v118, v118, s32, v254
    v_mfma_f32_32x32x16_bf16 v[144:159], v[204:207], v[20:23], v[144:159]
    v_fma_f32 v119, v119, s32, v254
    v_exp_f32 v116, v116
    v_exp_f32 v117, v117
    v_add_f32 v232, v232, v114
    v_add_f32 v233, v233, v115
    s_waitcnt lgkmcnt(4)
    v_mfma_f32_32x32x16_bf16 v[128:143], v[208:211], v[24:27], v[128:143]
    v_cvt_pk_bf16_f32 v57, v114, v115
    v_fma_f32 v120, v120, s32, v254
    v_fma_f32 v121, v121, s32, v254
    v_exp_f32 v118, v118
    v_exp_f32 v119, v119
    v_mfma_f32_32x32x16_bf16 v[144:159], v[212:215], v[24:27], v[144:159]
    s_waitcnt lgkmcnt(0)
    s_waitcnt vmcnt(12)
    s_barrier
    v_add_u32 v248, 81920, v246
    v_xor_b32 v249, 32, v248
    v_xor_b32 v250, 64, v248
    v_xor_b32 v251, 0x60, v248
    ds_read_b64_tr_b16 v[192:193], v248 offset:0
    v_add_f32 v230, v230, v116
    ds_read_b64_tr_b16 v[194:195], v249 offset:1024
    v_add_f32 v231, v231, v117
    v_cvt_pk_bf16_f32 v58, v116, v117
    ds_read_b64_tr_b16 v[196:197], v250 offset:0
    s_add_u32 m0, s30, 65536
    s_nop 0
    buffer_load_dwordx4 v240, s[48:51], 0 offen nt lds
    buffer_load_dwordx4 v241, s[48:51], 0 offen offset:1024 nt lds
    v_fma_f32 v122, v122, s32, v254
    ds_read_b64_tr_b16 v[198:199], v251 offset:1024
    v_fma_f32 v123, v123, s32, v254
    v_exp_f32 v120, v120
    v_mfma_f32_32x32x16_bf16 v[128:143], v[216:219], v[28:31], v[128:143]
    ds_read_b64_tr_b16 v[200:201], v248 offset:2048
    v_exp_f32 v121, v121
    ds_read_b64_tr_b16 v[202:203], v249 offset:3072
    v_add_f32 v232, v232, v118
    ds_read_b64_tr_b16 v[204:205], v250 offset:2048
    v_add_f32 v233, v233, v119
    ds_read_b64_tr_b16 v[206:207], v251 offset:3072
    v_cvt_pk_bf16_f32 v59, v118, v119
    v_fma_f32 v124, v124, s32, v254
    v_mfma_f32_32x32x16_bf16 v[144:159], v[220:223], v[28:31], v[144:159]
    ds_read_b64_tr_b16 v[208:209], v248 offset:4096
    v_fma_f32 v125, v125, s32, v254
    ds_read_b64_tr_b16 v[210:211], v249 offset:5120
    v_exp_f32 v122, v122
    ds_read_b64_tr_b16 v[212:213], v250 offset:4096
    v_exp_f32 v123, v123
    ds_read_b64_tr_b16 v[214:215], v251 offset:5120
    v_add_f32 v230, v230, v120
    v_add_f32 v231, v231, v121
    s_waitcnt lgkmcnt(8)
    v_mfma_f32_32x32x16_bf16 v[160:175], v[192:195], v[0:3], 0
    ds_read_b64_tr_b16 v[216:217], v248 offset:6144
    v_cvt_pk_bf16_f32 v60, v120, v121
    v_fma_f32 v126, v126, s32, v254
    ds_read_b64_tr_b16 v[218:219], v249 offset:7168
    v_fma_f32 v127, v127, s32, v254
    v_exp_f32 v124, v124
    v_exp_f32 v125, v125
    v_mfma_f32_32x32x16_bf16 v[176:191], v[196:199], v[0:3], 0
    ds_read_b64_tr_b16 v[220:221], v250 offset:6144
    v_add_f32 v232, v232, v122
    v_add_f32 v233, v233, v123
    v_cvt_pk_bf16_f32 v61, v122, v123
    ds_read_b64_tr_b16 v[222:223], v251 offset:7168
    v_fma_f32 v96, v96, s32, v254
    v_fma_f32 v97, v97, s32, v254
    v_exp_f32 v126, v126
    s_waitcnt lgkmcnt(8)
    v_mfma_f32_32x32x16_bf16 v[160:175], v[200:203], v[4:7], v[160:175]
    ds_read_b64_tr_b16 v[192:193], v248 offset:8192
    v_exp_f32 v127, v127
    v_add_f32 v230, v230, v124
    ds_read_b64_tr_b16 v[194:195], v249 offset:9216
    v_add_f32 v231, v231, v125
    v_cvt_pk_bf16_f32 v62, v124, v125
    v_fma_f32 v98, v98, s32, v254
    v_mfma_f32_32x32x16_bf16 v[176:191], v[204:207], v[4:7], v[176:191]
    ds_read_b64_tr_b16 v[196:197], v250 offset:8192
    v_fma_f32 v99, v99, s32, v254
    v_exp_f32 v96, v96
    v_exp_f32 v97, v97
    ds_read_b64_tr_b16 v[198:199], v251 offset:9216
    v_add_f32 v232, v232, v126
    v_add_f32 v233, v233, v127
    s_cmp_eq_u32 s33, 0
    s_cbranch_scc1 L_rs1
    v_mul_f32 v128, v128, v252
    v_mul_f32 v129, v129, v252
    v_mul_f32 v130, v130, v252
    v_mul_f32 v131, v131, v252
    v_mul_f32 v132, v132, v252
    v_mul_f32 v133, v133, v252
    v_mul_f32 v134, v134, v252
    v_mul_f32 v135, v135, v252
    v_mul_f32 v136, v136, v252
    v_mul_f32 v137, v137, v252
    v_mul_f32 v138, v138, v252
    v_mul_f32 v139, v139, v252
    v_mul_f32 v140, v140, v252
    v_mul_f32 v141, v141, v252
    v_mul_f32 v142, v142, v252
    v_mul_f32 v143, v143, v252
    v_mul_f32 v144, v144, v252
    v_mul_f32 v145, v145, v252
    v_mul_f32 v146, v146, v252
    v_mul_f32 v147, v147, v252
    v_mul_f32 v148, v148, v252
    v_mul_f32 v149, v149, v252
    v_mul_f32 v150, v150, v252
    v_mul_f32 v151, v151, v252
    v_mul_f32 v152, v152, v252
    v_mul_f32 v153, v153, v252
    v_mul_f32 v154, v154, v252
    v_mul_f32 v155, v155, v252
    v_mul_f32 v156, v156, v252
    v_mul_f32 v157, v157, v252
    v_mul_f32 v158, v158, v252
    v_mul_f32 v159, v159, v252
L_rs1:
    s_waitcnt lgkmcnt(8)
    v_mfma_f32_32x32x16_bf16 v[160:175], v[208:211], v[8:11], v[160:175]
    ds_read_b64_tr_b16 v[200:201], v248 offset:10240
    v_cvt_pk_bf16_f32 v63, v126, v127
    v_fma_f32 v100, v100, s32, v254
    ds_read_b64_tr_b16 v[202:203], v249 offset:11264
    v_fma_f32 v101, v101, s32, v254
    v_exp_f32 v98, v98
    v_exp_f32 v99, v99
    v_mfma_f32_32x32x16_bf16 v[176:191], v[212:215], v[8:11], v[176:191]
    ds_read_b64_tr_b16 v[204:205], v250 offset:10240
    v_add_f32 v230, v230, v96
    v_add_f32 v231, v231, v97
    v_cvt_pk_bf16_f32 v48, v96, v97
    ds_read_b64_tr_b16 v[206:207], v251 offset:11264
    v_fma_f32 v102, v102, s32, v254
    v_fma_f32 v103, v103, s32, v254
    v_exp_f32 v100, v100
    s_waitcnt lgkmcnt(8)
    v_mfma_f32_32x32x16_bf16 v[160:175], v[216:219], v[12:15], v[160:175]
    ds_read_b64_tr_b16 v[208:209], v248 offset:12288
    v_exp_f32 v101, v101
    v_add_f32 v232, v232, v98
    ds_read_b64_tr_b16 v[210:211], v249 offset:13312
    v_add_f32 v233, v233, v99
    v_cvt_pk_bf16_f32 v49, v98, v99
    v_fma_f32 v104, v104, s32, v254
    v_mfma_f32_32x32x16_bf16 v[176:191], v[220:223], v[12:15], v[176:191]
    ds_read_b64_tr_b16 v[212:213], v250 offset:12288
    v_fma_f32 v105, v105, s32, v254
    v_exp_f32 v102, v102
    ds_read_b64_tr_b16 v[214:215], v251 offset:13312
    v_exp_f32 v103, v103
    v_add_f32 v230, v230, v100
    s_waitcnt lgkmcnt(8)
    v_mfma_f32_32x32x16_bf16 v[160:175], v[192:195], v[16:19], v[160:175]
    ds_read_b64_tr_b16 v[216:217], v248 offset:14336
    v_add_f32 v231, v231, v101
    v_cvt_pk_bf16_f32 v50, v100, v101
    v_fma_f32 v106, v106, s32, v254
    ds_read_b64_tr_b16 v[218:219], v249 offset:15360
    v_fma_f32 v107, v107, s32, v254
    v_exp_f32 v104, v104
    v_exp_f32 v105, v105
    v_mfma_f32_32x32x16_bf16 v[176:191], v[196:199], v[16:19], v[176:191]
    ds_read_b64_tr_b16 v[220:221], v250 offset:14336
    v_add_f32 v232, v232, v102
    v_add_f32 v233, v233, v103
    v_cvt_pk_bf16_f32 v51, v102, v103
    ds_read_b64_tr_b16 v[222:223], v251 offset:15360
    v_fma_f32 v108, v108, s32, v254
    v_fma_f32 v109, v109, s32, v254
    v_exp_f32 v106, v106
    s_waitcnt lgkmcnt(8)
    v_mfma_f32_32x32x16_bf16 v[160:175], v[200:203], v[20:23], v[160:175]
    v_exp_f32 v107, v107
    v_add_f32 v230, v230, v104
    v_add_f32 v231, v231, v105
    v_cvt_pk_bf16_f32 v52, v104, v105
    v_fma_f32 v110, v110, s32, v254
    v_mfma_f32_32x32x16_bf16 v[176:191], v[204:207], v[20:23], v[176:191]
    v_fma_f32 v111, v111, s32, v254
    v_exp_f32 v108, v108
    v_exp_f32 v109, v109
    v_add_f32 v232, v232, v106
    s_waitcnt lgkmcnt(4)
    v_mfma_f32_32x32x16_bf16 v[160:175], v[208:211], v[24:27], v[160:175]
    v_add_f32 v233, v233, v107
    v_cvt_pk_bf16_f32 v53, v106, v107
    v_fma_f32 v80, v80, s32, v254
    v_fma_f32 v81, v81, s32, v254
    v_exp_f32 v110, v110
    v_exp_f32 v111, v111
    v_mfma_f32_32x32x16_bf16 v[176:191], v[212:215], v[24:27], v[176:191]
    s_waitcnt lgkmcnt(0)
    s_waitcnt vmcnt(12)
    s_barrier
    v_add_u32 v248, 98304, v246
    v_xor_b32 v249, 32, v248
    v_xor_b32 v250, 64, v248
    v_xor_b32 v251, 0x60, v248
    ds_read_b64_tr_b16 v[192:193], v248 offset:0
    v_add_f32 v230, v230, v108
    ds_read_b64_tr_b16 v[194:195], v249 offset:1024
    v_add_f32 v231, v231, v109
    v_cvt_pk_bf16_f32 v54, v108, v109
    ds_read_b64_tr_b16 v[196:197], v250 offset:0
    s_add_u32 m0, s30, 81920
    s_mov_b32 s41, 128
    buffer_load_dwordx4 v240, s[44:47], s41 offen nt lds
    buffer_load_dwordx4 v241, s[44:47], s41 offen offset:1024 nt lds
    v_fma_f32 v82, v82, s32, v254
    ds_read_b64_tr_b16 v[198:199], v251 offset:1024
    v_fma_f32 v83, v83, s32, v254
    v_exp_f32 v80, v80
    v_mfma_f32_32x32x16_bf16 v[160:175], v[216:219], v[28:31], v[160:175]
    ds_read_b64_tr_b16 v[200:201], v248 offset:2048
    v_exp_f32 v81, v81
    ds_read_b64_tr_b16 v[202:203], v249 offset:3072
    v_add_f32 v232, v232, v110
    ds_read_b64_tr_b16 v[204:205], v250 offset:2048
    v_add_f32 v233, v233, v111
    ds_read_b64_tr_b16 v[206:207], v251 offset:3072
    v_cvt_pk_bf16_f32 v55, v110, v111
    v_mfma_f32_32x32x16_bf16 v[176:191], v[220:223], v[28:31], v[176:191]
    ds_read_b64_tr_b16 v[208:209], v248 offset:4096
    v_fma_f32 v84, v84, s32, v254
    ds_read_b64_tr_b16 v[210:211], v249 offset:5120
    v_fma_f32 v85, v85, s32, v254
    ds_read_b64_tr_b16 v[212:213], v250 offset:4096
    v_exp_f32 v82, v82
    ds_read_b64_tr_b16 v[214:215], v251 offset:5120
    v_exp_f32 v83, v83
    s_waitcnt lgkmcnt(8)
    v_mfma_f32_32x32x16_bf16 v[96:111], v[192:195], v[0:3], 0
    ds_read_b64_tr_b16 v[216:217], v248 offset:6144
    v_add_f32 v230, v230, v80
    v_add_f32 v231, v231, v81
    ds_read_b64_tr_b16 v[218:219], v249 offset:7168
    v_cvt_pk_bf16_f32 v40, v80, v81
    v_fma_f32 v86, v86, s32, v254
    v_mfma_f32_32x32x16_bf16 v[112:127], v[196:199], v[0:3], 0
    ds_read_b64_tr_b16 v[220:221], v250 offset:6144
    v_fma_f32 v87, v87, s32, v254
    ds_read_b64_tr_b16 v[222:223], v251 offset:7168
    v_exp_f32 v84, v84
    v_exp_f32 v85, v85
    s_waitcnt lgkmcnt(8)
    v_mfma_f32_32x32x16_bf16 v[96:111], v[200:203], v[4:7], v[96:111]
    ds_read_b64_tr_b16 v[192:193], v248 offset:8192
    v_add_f32 v232, v232, v82
    v_add_f32 v233, v233, v83
    ds_read_b64_tr_b16 v[194:195], v249 offset:9216
    v_cvt_pk_bf16_f32 v41, v82, v83
    v_fma_f32 v88, v88, s32, v254
    v_fma_f32 v89, v89, s32, v254
    v_mfma_f32_32x32x16_bf16 v[112:127], v[204:207], v[4:7], v[112:127]
    ds_read_b64_tr_b16 v[196:197], v250 offset:8192
    v_exp_f32 v86, v86
    v_exp_f32 v87, v87
    ds_read_b64_tr_b16 v[198:199], v251 offset:9216
    v_add_f32 v230, v230, v84
    s_cmp_eq_u32 s33, 0
    s_cbranch_scc1 L_rs2
    v_mul_f32 v160, v160, v252
    v_mul_f32 v161, v161, v252
    v_mul_f32 v162, v162, v252
    v_mul_f32 v163, v163, v252
    v_mul_f32 v164, v164, v252
    v_mul_f32 v165, v165, v252
    v_mul_f32 v166, v166, v252
    v_mul_f32 v167, v167, v252
    v_mul_f32 v168, v168, v252
    v_mul_f32 v169, v169, v252
    v_mul_f32 v170, v170, v252
    v_mul_f32 v171, v171, v252
    v_mul_f32 v172, v172, v252
    v_mul_f32 v173, v173, v252
    v_mul_f32 v174, v174, v252
    v_mul_f32 v175, v175, v252
    v_mul_f32 v176, v176, v252
    v_mul_f32 v177, v177, v252
    v_mul_f32 v178, v178, v252
    v_mul_f32 v179, v179, v252
    v_mul_f32 v180, v180, v252
    v_mul_f32 v181, v181, v252
    v_mul_f32 v182, v182, v252
    v_mul_f32 v183, v183, v252
    v_mul_f32 v184, v184, v252
    v_mul_f32 v185, v185, v252
    v_mul_f32 v186, v186, v252
    v_mul_f32 v187, v187, v252
    v_mul_f32 v188, v188, v252
    v_mul_f32 v189, v189, v252
    v_mul_f32 v190, v190, v252
    v_mul_f32 v191, v191, v252
L_rs2:
    s_waitcnt lgkmcnt(8)
    v_mfma_f32_32x32x16_bf16 v[96:111], v[208:211], v[8:11], v[96:111]
    ds_read_b64_tr_b16 v[200:201], v248 offset:10240
    v_add_f32 v231, v231, v85
    v_cvt_pk_bf16_f32 v42, v84, v85
    ds_read_b64_tr_b16 v[202:203], v249 offset:11264
    v_fma_f32 v90, v90, s32, v254
    v_fma_f32 v91, v91, s32, v254
    v_exp_f32 v88, v88
    v_mfma_f32_32x32x16_bf16 v[112:127], v[212:215], v[8:11], v[112:127]
    ds_read_b64_tr_b16 v[204:205], v250 offset:10240
    v_exp_f32 v89, v89
    ds_read_b64_tr_b16 v[206:207], v251 offset:11264
    v_add_f32 v232, v232, v86
    v_add_f32 v233, v233, v87
    s_waitcnt lgkmcnt(8)
    v_mfma_f32_32x32x16_bf16 v[96:111], v[216:219], v[12:15], v[96:111]
    ds_read_b64_tr_b16 v[208:209], v248 offset:12288
    v_cvt_pk_bf16_f32 v43, v86, v87
    v_fma_f32 v92, v92, s32, v254
    ds_read_b64_tr_b16 v[210:211], v249 offset:13312
    v_fma_f32 v93, v93, s32, v254
    v_exp_f32 v90, v90
    v_mfma_f32_32x32x16_bf16 v[112:127], v[220:223], v[12:15], v[112:127]
    ds_read_b64_tr_b16 v[212:213], v250 offset:12288
    v_exp_f32 v91, v91
    ds_read_b64_tr_b16 v[214:215], v251 offset:13312
    v_add_f32 v230, v230, v88
    v_add_f32 v231, v231, v89
    s_waitcnt lgkmcnt(8)
    v_mfma_f32_32x32x16_bf16 v[96:111], v[192:195], v[16:19], v[96:111]
    ds_read_b64_tr_b16 v[216:217], v248 offset:14336
    v_cvt_pk_bf16_f32 v44, v88, v89
    v_fma_f32 v94, v94, s32, v254
    ds_read_b64_tr_b16 v[218:219], v249 offset:15360
    v_fma_f32 v95, v95, s32, v254
    v_exp_f32 v92, v92
    v_mfma_f32_32x32x16_bf16 v[112:127], v[196:199], v[16:19], v[112:127]
    ds_read_b64_tr_b16 v[220:221], v250 offset:14336
    v_exp_f32 v93, v93
    v_add_f32 v232, v232, v90
    ds_read_b64_tr_b16 v[222:223], v251 offset:15360
    v_add_f32 v233, v233, v91
    v_cvt_pk_bf16_f32 v45, v90, v91
    s_waitcnt lgkmcnt(8)
    v_mfma_f32_32x32x16_bf16 v[96:111], v[200:203], v[20:23], v[96:111]
    v_fma_f32 v64, v64, s32, v254
    v_fma_f32 v65, v65, s32, v254
    v_exp_f32 v94, v94
    v_exp_f32 v95, v95
    v_mfma_f32_32x32x16_bf16 v[112:127], v[204:207], v[20:23], v[112:127]
    v_add_f32 v230, v230, v92
    v_add_f32 v231, v231, v93
    v_cvt_pk_bf16_f32 v46, v92, v93
    v_fma_f32 v66, v66, s32, v254
    s_waitcnt lgkmcnt(4)
    v_mfma_f32_32x32x16_bf16 v[96:111], v[208:211], v[24:27], v[96:111]
    v_fma_f32 v67, v67, s32, v254
    v_exp_f32 v64, v64
    v_exp_f32 v65, v65
    v_mfma_f32_32x32x16_bf16 v[112:127], v[212:215], v[24:27], v[112:127]
    s_waitcnt lgkmcnt(0)
    s_waitcnt vmcnt(12)
    s_barrier
    v_add_u32 v248, 114688, v246
    v_xor_b32 v249, 32, v248
    v_xor_b32 v250, 64, v248
    v_xor_b32 v251, 0x60, v248
    ds_read_b64_tr_b16 v[192:193], v248 offset:14336
    v_add_f32 v232, v232, v94
    ds_read_b64_tr_b16 v[194:195], v249 offset:15360
    v_add_f32 v233, v233, v95
    s_add_u32 m0, s30, 98304
    s_mov_b32 s41, 49280
    buffer_load_dwordx4 v240, s[44:47], s41 offen nt lds
    buffer_load_dwordx4 v241, s[44:47], s41 offen offset:1024 nt lds
    ds_read_b64_tr_b16 v[196:197], v250 offset:14336
    v_cvt_pk_bf16_f32 v47, v94, v95
    ds_read_b64_tr_b16 v[198:199], v251 offset:15360
    v_fma_f32 v68, v68, s32, v254
    v_fma_f32 v69, v69, s32, v254
    v_mfma_f32_32x32x16_bf16 v[96:111], v[216:219], v[28:31], v[96:111]
    ds_read_b64_tr_b16 v[200:201], v248 offset:12288
    ds_read_b64_tr_b16 v[202:203], v249 offset:13312
    v_exp_f32 v66, v66
    ds_read_b64_tr_b16 v[204:205], v250 offset:12288
    v_exp_f32 v67, v67
    ds_read_b64_tr_b16 v[206:207], v251 offset:13312
    v_add_f32 v230, v230, v64
    v_mfma_f32_32x32x16_bf16 v[112:127], v[220:223], v[28:31], v[112:127]
    ds_read_b64_tr_b16 v[208:209], v248 offset:10240
    v_add_f32 v231, v231, v65
    ds_read_b64_tr_b16 v[210:211], v249 offset:11264
    v_cvt_pk_bf16_f32 v32, v64, v65
    ds_read_b64_tr_b16 v[212:213], v250 offset:10240
    v_fma_f32 v70, v70, s32, v254
    ds_read_b64_tr_b16 v[214:215], v251 offset:11264
    v_fma_f32 v71, v71, s32, v254
    s_waitcnt lgkmcnt(8)
    v_mfma_f32_32x32x16_bf16 v[128:143], v[192:195], v[60:63], v[128:143]
    ds_read_b64_tr_b16 v[216:217], v248 offset:8192
    v_exp_f32 v68, v68
    ds_read_b64_tr_b16 v[218:219], v249 offset:9216
    v_exp_f32 v69, v69
    v_add_f32 v232, v232, v66
    v_mfma_f32_32x32x16_bf16 v[144:159], v[196:199], v[60:63], v[144:159]
    ds_read_b64_tr_b16 v[220:221], v250 offset:8192
    v_add_f32 v233, v233, v67
    v_cvt_pk_bf16_f32 v33, v66, v67
    ds_read_b64_tr_b16 v[222:223], v251 offset:9216
    v_fma_f32 v72, v72, s32, v254
    v_fma_f32 v73, v73, s32, v254
    v_exp_f32 v70, v70
    s_waitcnt lgkmcnt(8)
    v_mfma_f32_32x32x16_bf16 v[128:143], v[200:203], v[56:59], v[128:143]
    ds_read_b64_tr_b16 v[192:193], v248 offset:6144
    v_exp_f32 v71, v71
    ds_read_b64_tr_b16 v[194:195], v249 offset:7168
    v_add_f32 v230, v230, v68
    v_add_f32 v231, v231, v69
    v_mfma_f32_32x32x16_bf16 v[144:159], v[204:207], v[56:59], v[144:159]
    ds_read_b64_tr_b16 v[196:197], v250 offset:6144
    v_cvt_pk_bf16_f32 v34, v68, v69
    v_fma_f32 v74, v74, s32, v254
    ds_read_b64_tr_b16 v[198:199], v251 offset:7168
    v_fma_f32 v75, v75, s32, v254
    v_exp_f32 v72, v72
    s_cmp_eq_u32 s33, 0
    s_cbranch_scc1 L_rs3
    v_mul_f32 v96, v96, v252
    v_mul_f32 v97, v97, v252
    v_mul_f32 v98, v98, v252
    v_mul_f32 v99, v99, v252
    v_mul_f32 v100, v100, v252
    v_mul_f32 v101, v101, v252
    v_mul_f32 v102, v102, v252
    v_mul_f32 v103, v103, v252
    v_mul_f32 v104, v104, v252
    v_mul_f32 v105, v105, v252
    v_mul_f32 v106, v106, v252
    v_mul_f32 v107, v107, v252
    v_mul_f32 v108, v108, v252
    v_mul_f32 v109, v109, v252
    v_mul_f32 v110, v110, v252
    v_mul_f32 v111, v111, v252
    v_mul_f32 v112, v112, v252
    v_mul_f32 v113, v113, v252
    v_mul_f32 v114, v114, v252
    v_mul_f32 v115, v115, v252
    v_mul_f32 v116, v116, v252
    v_mul_f32 v117, v117, v252
    v_mul_f32 v118, v118, v252
    v_mul_f32 v119, v119, v252
    v_mul_f32 v120, v120, v252
    v_mul_f32 v121, v121, v252
    v_mul_f32 v122, v122, v252
    v_mul_f32 v123, v123, v252
    v_mul_f32 v124, v124, v252
    v_mul_f32 v125, v125, v252
    v_mul_f32 v126, v126, v252
    v_mul_f32 v127, v127, v252
L_rs3:
    s_waitcnt lgkmcnt(8)
    v_mfma_f32_32x32x16_bf16 v[128:143], v[208:211], v[52:55], v[128:143]
    ds_read_b64_tr_b16 v[200:201], v248 offset:4096
    v_exp_f32 v73, v73
    v_add_f32 v232, v232, v70
    ds_read_b64_tr_b16 v[202:203], v249 offset:5120
    v_add_f32 v233, v233, v71
    v_cvt_pk_bf16_f32 v35, v70, v71
    v_mfma_f32_32x32x16_bf16 v[144:159], v[212:215], v[52:55], v[144:159]
    ds_read_b64_tr_b16 v[204:205], v250 offset:4096
    v_fma_f32 v76, v76, s32, v254
    v_fma_f32 v77, v77, s32, v254
    ds_read_b64_tr_b16 v[206:207], v251 offset:5120
    v_exp_f32 v74, v74
    v_exp_f32 v75, v75
    s_waitcnt lgkmcnt(8)
    v_mfma_f32_32x32x16_bf16 v[128:143], v[216:219], v[48:51], v[128:143]
    ds_read_b64_tr_b16 v[208:209], v248 offset:2048
    v_add_f32 v230, v230, v72
    ds_read_b64_tr_b16 v[210:211], v249 offset:3072
    v_add_f32 v231, v231, v73
    v_cvt_pk_bf16_f32 v36, v72, v73
    v_mfma_f32_32x32x16_bf16 v[144:159], v[220:223], v[48:51], v[144:159]
    ds_read_b64_tr_b16 v[212:213], v250 offset:2048
    v_fma_f32 v78, v78, s32, v254
    v_fma_f32 v79, v79, s32, v254
    ds_read_b64_tr_b16 v[214:215], v251 offset:3072
    v_exp_f32 v76, v76
    v_exp_f32 v77, v77
    s_waitcnt lgkmcnt(8)
    v_mfma_f32_32x32x16_bf16 v[128:143], v[192:195], v[44:47], v[128:143]
    ds_read_b64_tr_b16 v[216:217], v248 offset:0
    v_add_f32 v232, v232, v74
    v_add_f32 v233, v233, v75
    ds_read_b64_tr_b16 v[218:219], v249 offset:1024
    v_cvt_pk_bf16_f32 v37, v74, v75
    v_exp_f32 v78, v78
    v_mfma_f32_32x32x16_bf16 v[144:159], v[196:199], v[44:47], v[144:159]
    ds_read_b64_tr_b16 v[220:221], v250 offset:0
    v_exp_f32 v79, v79
    ds_read_b64_tr_b16 v[222:223], v251 offset:1024
    v_add_f32 v230, v230, v76
    v_add_f32 v231, v231, v77
    s_waitcnt lgkmcnt(8)
    v_mfma_f32_32x32x16_bf16 v[128:143], v[200:203], v[40:43], v[128:143]
    v_cvt_pk_bf16_f32 v38, v76, v77
    s_nop 0
    v_add_f32 v232, v232, v78
    v_add_f32 v233, v233, v79
    v_cvt_pk_bf16_f32 v39, v78, v79
    v_mfma_f32_32x32x16_bf16 v[144:159], v[204:207], v[40:43], v[144:159]
    v_add_f32 v230, v230, v232
    v_add_f32 v231, v231, v233
    v_add_f32 v228, v230, v231
    s_waitcnt lgkmcnt(4)
    v_mfma_f32_32x32x16_bf16 v[128:143], v[208:211], v[36:39], v[128:143]
    v_fma_f32 v228, v247, v252, v228
    v_mov_b32 v229, v228
    v_mfma_f32_32x32x16_bf16 v[144:159], v[212:215], v[36:39], v[144:159]
    s_waitcnt lgkmcnt(0)
    s_waitcnt vmcnt(12)
    s_barrier
    v_mov_b32 v248, v246
    v_xor_b32 v249, 32, v248
    v_xor_b32 v250, 64, v248
    v_xor_b32 v251, 0x60, v248
    ds_read_b64_tr_b16 v[192:193], v248 offset:14336
    ds_read_b64_tr_b16 v[194:195], v249 offset:15360
    s_nop 1
    ds_read_b64_tr_b16 v[196:197], v250 offset:14336
    s_add_u32 m0, s30, 114688
    s_mov_b32 s41, 128
    buffer_load_dwordx4 v240, s[48:51], s41 offen nt lds
    buffer_load_dwordx4 v241, s[48:51], s41 offen offset:1024 nt lds
    ds_read_b64_tr_b16 v[198:199], v251 offset:15360
    v_permlane32_swap_b32 v228, v229
    v_mfma_f32_32x32x16_bf16 v[128:143], v[216:219], v[32:35], v[128:143]
    ds_read_b64_tr_b16 v[200:201], v248 offset:12288
    ds_read_b64_tr_b16 v[202:203], v249 offset:13312
    s_nop 0
    ds_read_b64_tr_b16 v[204:205], v250 offset:12288
    ds_read_b64_tr_b16 v[206:207], v251 offset:13312
    v_add_f32 v228, v228, v229
    v_mfma_f32_32x32x16_bf16 v[144:159], v[220:223], v[32:35], v[144:159]
    ds_read_b64_tr_b16 v[208:209], v248 offset:10240
    ds_read_b64_tr_b16 v[210:211], v249 offset:11264
    ds_read_b64_tr_b16 v[212:213], v250 offset:10240
    ds_read_b64_tr_b16 v[214:215], v251 offset:11264
    v_rcp_f32 v254, v228
    s_waitcnt lgkmcnt(8)
    v_mfma_f32_32x32x16_bf16 v[160:175], v[192:195], v[60:63], v[160:175]
    ds_read_b64_tr_b16 v[216:217], v248 offset:8192
    ds_read_b64_tr_b16 v[218:219], v249 offset:9216
    v_mfma_f32_32x32x16_bf16 v[176:191], v[196:199], v[60:63], v[176:191]
    ds_read_b64_tr_b16 v[220:221], v250 offset:8192
    v_mul_f32 v128, v128, v254
    v_mul_f32 v129, v129, v254
    ds_read_b64_tr_b16 v[222:223], v251 offset:9216
    v_mul_f32 v130, v130, v254
    v_mul_f32 v131, v131, v254
    s_waitcnt lgkmcnt(8)
    v_mfma_f32_32x32x16_bf16 v[160:175], v[200:203], v[56:59], v[160:175]
    ds_read_b64_tr_b16 v[192:193], v248 offset:6144
    v_cvt_pk_bf16_f32 v128, v128, v129
    ds_read_b64_tr_b16 v[194:195], v249 offset:7168
    v_cvt_pk_bf16_f32 v129, v130, v131
    ds_write_b64 v243, v[128:129]
    v_mfma_f32_32x32x16_bf16 v[176:191], v[204:207], v[56:59], v[176:191]
    ds_read_b64_tr_b16 v[196:197], v250 offset:6144
    v_mul_f32 v132, v132, v254
    v_mul_f32 v133, v133, v254
    ds_read_b64_tr_b16 v[198:199], v251 offset:7168
    v_mul_f32 v134, v134, v254
    v_mul_f32 v135, v135, v254
    s_waitcnt lgkmcnt(9)
    v_mfma_f32_32x32x16_bf16 v[160:175], v[208:211], v[52:55], v[160:175]
    ds_read_b64_tr_b16 v[200:201], v248 offset:4096
    v_cvt_pk_bf16_f32 v132, v132, v133
    v_cvt_pk_bf16_f32 v133, v134, v135
    ds_read_b64_tr_b16 v[202:203], v249 offset:5120
    v_xor_b32 v134, 16, v243
    ds_write_b64 v134, v[132:133]
    v_mfma_f32_32x32x16_bf16 v[176:191], v[212:215], v[52:55], v[176:191]
    ds_read_b64_tr_b16 v[204:205], v250 offset:4096
    v_mul_f32 v136, v136, v254
    v_mul_f32 v137, v137, v254
    ds_read_b64_tr_b16 v[206:207], v251 offset:5120
    v_mul_f32 v138, v138, v254
    v_mul_f32 v139, v139, v254
    s_waitcnt lgkmcnt(10)
    v_mfma_f32_32x32x16_bf16 v[160:175], v[216:219], v[48:51], v[160:175]
    ds_read_b64_tr_b16 v[208:209], v248 offset:2048
    v_cvt_pk_bf16_f32 v136, v136, v137
    v_cvt_pk_bf16_f32 v137, v138, v139
    ds_read_b64_tr_b16 v[210:211], v249 offset:3072
    v_xor_b32 v138, 32, v243
    ds_write_b64 v138, v[136:137]
    v_mfma_f32_32x32x16_bf16 v[176:191], v[220:223], v[48:51], v[176:191]
    ds_read_b64_tr_b16 v[212:213], v250 offset:2048
    v_mul_f32 v140, v140, v254
    v_mul_f32 v141, v141, v254
    ds_read_b64_tr_b16 v[214:215], v251 offset:3072
    v_mul_f32 v142, v142, v254
    v_mul_f32 v143, v143, v254
    s_waitcnt lgkmcnt(10)
    v_mfma_f32_32x32x16_bf16 v[160:175], v[192:195], v[44:47], v[160:175]
    ds_read_b64_tr_b16 v[216:217], v248 offset:0
    v_cvt_pk_bf16_f32 v140, v140, v141
    v_cvt_pk_bf16_f32 v141, v142, v143
    ds_read_b64_tr_b16 v[218:219], v249 offset:1024
    v_xor_b32 v142, 48, v243
    ds_write_b64 v142, v[140:141]
    v_mfma_f32_32x32x16_bf16 v[176:191], v[196:199], v[44:47], v[176:191]
    ds_read_b64_tr_b16 v[220:221], v250 offset:0
    v_mul_f32 v144, v144, v254
    v_mul_f32 v145, v145, v254
    ds_read_b64_tr_b16 v[222:223], v251 offset:1024
    v_mul_f32 v146, v146, v254
    v_mul_f32 v147, v147, v254
    s_waitcnt lgkmcnt(10)
    v_mfma_f32_32x32x16_bf16 v[160:175], v[200:203], v[40:43], v[160:175]
    v_cvt_pk_bf16_f32 v144, v144, v145
    v_cvt_pk_bf16_f32 v145, v146, v147
    v_xor_b32 v146, 64, v243
    ds_write_b64 v146, v[144:145]
    v_mfma_f32_32x32x16_bf16 v[176:191], v[204:207], v[40:43], v[176:191]
    v_mul_f32 v148, v148, v254
    v_mul_f32 v149, v149, v254
    v_mul_f32 v150, v150, v254
    v_mul_f32 v151, v151, v254
    s_waitcnt lgkmcnt(6)
    v_mfma_f32_32x32x16_bf16 v[160:175], v[208:211], v[36:39], v[160:175]
    v_cvt_pk_bf16_f32 v148, v148, v149
    v_cvt_pk_bf16_f32 v149, v150, v151
    v_xor_b32 v150, 80, v243
    ds_write_b64 v150, v[148:149]
    v_mfma_f32_32x32x16_bf16 v[176:191], v[212:215], v[36:39], v[176:191]
    s_waitcnt lgkmcnt(2)
    s_waitcnt vmcnt(8)
    s_barrier
    s_add_u32 s40, s31, 32768
    v_add_u32 v248, s40, v245
    v_xor_b32 v249, 32, v248
    v_xor_b32 v250, 64, v248
    v_xor_b32 v251, 0x60, v248
    ds_read_b128 v[224:227], v248
    ds_read_b128 v[228:231], v249
    ds_read_b128 v[232:235], v250
    ds_read_b128 v[236:239], v251
    v_add_u32 v248, 16384, v246
    v_xor_b32 v249, 32, v248
    v_xor_b32 v250, 64, v248
    v_xor_b32 v251, 0x60, v248
    ds_read_b64_tr_b16 v[192:193], v248 offset:14336
    v_mul_f32 v152, v152, v254
    ds_read_b64_tr_b16 v[194:195], v249 offset:15360
    v_mul_f32 v153, v153, v254
    ds_read_b64_tr_b16 v[196:197], v250 offset:14336
    s_mov_b32 m0, s30
    s_mov_b32 s41, 256
    buffer_load_dwordx4 v240, s[44:47], s41 offen nt lds
    buffer_load_dwordx4 v241, s[44:47], s41 offen offset:1024 nt lds
    ds_read_b64_tr_b16 v[198:199], v251 offset:15360
    v_mul_f32 v154, v154, v254
    v_mul_f32 v155, v155, v254
    v_mfma_f32_32x32x16_bf16 v[160:175], v[216:219], v[32:35], v[160:175]
    ds_read_b64_tr_b16 v[200:201], v248 offset:12288
    v_cvt_pk_bf16_f32 v152, v152, v153
    ds_read_b64_tr_b16 v[202:203], v249 offset:13312
    v_cvt_pk_bf16_f32 v153, v154, v155
    ds_read_b64_tr_b16 v[204:205], v250 offset:12288
    v_xor_b32 v154, 96, v243
    ds_read_b64_tr_b16 v[206:207], v251 offset:13312
    ds_write_b64 v154, v[152:153]
    v_mfma_f32_32x32x16_bf16 v[176:191], v[220:223], v[32:35], v[176:191]
    ds_read_b64_tr_b16 v[208:209], v248 offset:10240
    v_mul_f32 v156, v156, v254
    ds_read_b64_tr_b16 v[210:211], v249 offset:11264
    v_mul_f32 v157, v157, v254
    ds_read_b64_tr_b16 v[212:213], v250 offset:10240
    v_mul_f32 v158, v158, v254
    ds_read_b64_tr_b16 v[214:215], v251 offset:11264
    v_mul_f32 v159, v159, v254
    s_waitcnt lgkmcnt(9)
    v_mfma_f32_32x32x16_bf16 v[96:111], v[192:195], v[60:63], v[96:111]
    ds_read_b64_tr_b16 v[216:217], v248 offset:8192
    v_cvt_pk_bf16_f32 v156, v156, v157
    v_cvt_pk_bf16_f32 v157, v158, v159
    ds_read_b64_tr_b16 v[218:219], v249 offset:9216
    v_xor_b32 v158, 112, v243
    ds_write_b64 v158, v[156:157]
    v_mfma_f32_32x32x16_bf16 v[112:127], v[196:199], v[60:63], v[112:127]
    ds_read_b64_tr_b16 v[220:221], v250 offset:8192
    ds_read_b128 v[64:67], v244 offset:0
    ds_read_b64_tr_b16 v[222:223], v251 offset:9216
    ds_read_b128 v[68:71], v244 offset:1024
    s_waitcnt lgkmcnt(12)
    v_mfma_f32_32x32x16_bf16 v[96:111], v[200:203], v[56:59], v[96:111]
    ds_read_b64_tr_b16 v[192:193], v248 offset:6144
    ds_read_b128 v[72:75], v244 offset:2048
    ds_read_b128 v[76:79], v244 offset:3072
    v_mul_f32 v160, v160, v254
    ds_read_b64_tr_b16 v[194:195], v249 offset:7168
    v_mul_f32 v161, v161, v254
    v_mul_f32 v162, v162, v254
    v_mul_f32 v163, v163, v254
    v_mfma_f32_32x32x16_bf16 v[112:127], v[204:207], v[56:59], v[112:127]
    ds_read_b64_tr_b16 v[196:197], v250 offset:6144
    v_cvt_pk_bf16_f32 v160, v160, v161
    ds_read_b64_tr_b16 v[198:199], v251 offset:7168
    v_cvt_pk_bf16_f32 v161, v162, v163
    ds_write_b64 v243, v[160:161]
    s_waitcnt lgkmcnt(14)
    v_mfma_f32_32x32x16_bf16 v[96:111], v[208:211], v[52:55], v[96:111]
    ds_read_b64_tr_b16 v[200:201], v248 offset:4096
    v_mul_f32 v164, v164, v254
    v_mul_f32 v165, v165, v254
    ds_read_b64_tr_b16 v[202:203], v249 offset:5120
    v_mul_f32 v166, v166, v254
    v_mul_f32 v167, v167, v254
    v_mfma_f32_32x32x16_bf16 v[112:127], v[212:215], v[52:55], v[112:127]
    ds_read_b64_tr_b16 v[204:205], v250 offset:4096
    v_cvt_pk_bf16_f32 v164, v164, v165
    v_cvt_pk_bf16_f32 v165, v166, v167
    ds_read_b64_tr_b16 v[206:207], v251 offset:5120
    v_xor_b32 v166, 16, v243
    ds_write_b64 v166, v[164:165]
    s_waitcnt lgkmcnt(13)
    v_mfma_f32_32x32x16_bf16 v[96:111], v[216:219], v[48:51], v[96:111]
    ds_read_b64_tr_b16 v[208:209], v248 offset:2048
    v_mul_f32 v168, v168, v254
    v_mul_f32 v169, v169, v254
    ds_read_b64_tr_b16 v[210:211], v249 offset:3072
    v_mul_f32 v170, v170, v254
    v_mul_f32 v171, v171, v254
    v_mfma_f32_32x32x16_bf16 v[112:127], v[220:223], v[48:51], v[112:127]
    ds_read_b64_tr_b16 v[212:213], v250 offset:2048
    v_cvt_pk_bf16_f32 v168, v168, v169
    v_cvt_pk_bf16_f32 v169, v170, v171
    ds_read_b64_tr_b16 v[214:215], v251 offset:3072
    v_xor_b32 v170, 32, v243
    ds_write_b64 v170, v[168:169]
    s_waitcnt lgkmcnt(11)
    v_mfma_f32_32x32x16_bf16 v[96:111], v[192:195], v[44:47], v[96:111]
    ds_read_b64_tr_b16 v[216:217], v248 offset:0
    v_mul_f32 v172, v172, v254
    v_mul_f32 v173, v173, v254
    ds_read_b64_tr_b16 v[218:219], v249 offset:1024
    v_mul_f32 v174, v174, v254
    v_mul_f32 v175, v175, v254
    v_mfma_f32_32x32x16_bf16 v[112:127], v[196:199], v[44:47], v[112:127]
    ds_read_b64_tr_b16 v[220:221], v250 offset:0
    v_cvt_pk_bf16_f32 v172, v172, v173
    v_cvt_pk_bf16_f32 v173, v174, v175
    ds_read_b64_tr_b16 v[222:223], v251 offset:1024
    v_xor_b32 v174, 48, v243
    ds_write_b64 v174, v[172:173]
    s_waitcnt lgkmcnt(11)
    v_mfma_f32_32x32x16_bf16 v[96:111], v[200:203], v[40:43], v[96:111]
    v_mul_f32 v176, v176, v254
    v_mul_f32 v177, v177, v254
    v_mul_f32 v178, v178, v254
    v_mul_f32 v179, v179, v254
    v_mfma_f32_32x32x16_bf16 v[112:127], v[204:207], v[40:43], v[112:127]
    v_cvt_pk_bf16_f32 v176, v176, v177
    v_cvt_pk_bf16_f32 v177, v178, v179
    v_xor_b32 v178, 64, v243
    ds_write_b64 v178, v[176:177]
    s_waitcnt lgkmcnt(7)
    v_mfma_f32_32x32x16_bf16 v[96:111], v[208:211], v[36:39], v[96:111]
    v_mul_f32 v180, v180, v254
    v_mul_f32 v181, v181, v254
    v_mul_f32 v182, v182, v254
    v_mul_f32 v183, v183, v254
    v_mfma_f32_32x32x16_bf16 v[112:127], v[212:215], v[36:39], v[112:127]
    s_waitcnt lgkmcnt(2)
    s_waitcnt vmcnt(4)
    s_barrier
    s_add_u32 s40, s31, 81920
    v_add_u32 v248, s40, v245
    v_xor_b32 v249, 32, v248
    v_xor_b32 v250, 64, v248
    v_xor_b32 v251, 0x60, v248
    ds_read_b128 v[128:131], v248
    ds_read_b128 v[132:135], v249
    ds_read_b128 v[136:139], v250
    ds_read_b128 v[140:143], v251
    v_add_u32 v248, 65536, v245
    v_xor_b32 v249, 32, v248
    v_xor_b32 v250, 64, v248
    v_xor_b32 v251, 0x60, v248
    ds_read_b128 v[192:195], v248 offset:0
    v_cvt_pk_bf16_f32 v180, v180, v181
    v_cvt_pk_bf16_f32 v181, v182, v183
    ds_read_b128 v[196:199], v249 offset:0
    s_add_u32 m0, s30, 16384
    s_mov_b32 s41, 49408
    buffer_load_dwordx4 v240, s[44:47], s41 offen nt lds
    buffer_load_dwordx4 v241, s[44:47], s41 offen offset:1024 nt lds
    v_xor_b32 v182, 80, v243
    ds_write_b64 v182, v[180:181]
    v_mfma_f32_32x32x16_bf16 v[96:111], v[216:219], v[32:35], v[96:111]
    ds_read_b128 v[200:203], v250 offset:0
    v_mul_f32 v184, v184, v254
    v_mul_f32 v185, v185, v254
    ds_read_b128 v[204:207], v251 offset:0
    s_add_u32 m0, s30, 32768
    s_mov_b32 s41, 256
    buffer_load_dwordx4 v240, s[48:51], s41 offen nt lds
    buffer_load_dwordx4 v241, s[48:51], s41 offen offset:1024 nt lds
    v_mul_f32 v186, v186, v254
    v_mul_f32 v187, v187, v254
    v_mfma_f32_32x32x16_bf16 v[112:127], v[220:223], v[32:35], v[112:127]
    ds_read_b128 v[208:211], v248 offset:4096
    v_cvt_pk_bf16_f32 v184, v184, v185
    v_cvt_pk_bf16_f32 v185, v186, v187
    ds_read_b128 v[212:215], v249 offset:4096
    s_add_u32 m0, s30, 49152
    s_mov_b32 s41, 49152
    buffer_load_dwordx4 v240, s[48:51], s41 offen nt lds
    buffer_load_dwordx4 v241, s[48:51], s41 offen offset:1024 nt lds
    v_xor_b32 v186, 96, v243
    ds_write_b64 v186, v[184:185]
    s_waitcnt lgkmcnt(6)
    v_mfma_f32_32x32x16_bf16 v[0:15], v[192:195], v[224:227], 0
    ds_read_b128 v[216:219], v250 offset:4096
    v_mul_f32 v188, v188, v254
    v_mul_f32 v189, v189, v254
    v_mul_f32 v190, v190, v254
    v_mul_f32 v191, v191, v254
    v_mfma_f32_32x32x16_bf16 v[0:15], v[196:199], v[228:231], v[0:15]
    ds_read_b128 v[220:223], v251 offset:4096
    v_cvt_pk_bf16_f32 v188, v188, v189
    v_cvt_pk_bf16_f32 v189, v190, v191
    v_xor_b32 v190, 112, v243
    ds_write_b64 v190, v[188:189]
    s_waitcnt lgkmcnt(6)
    v_mfma_f32_32x32x16_bf16 v[0:15], v[200:203], v[232:235], v[0:15]
    ds_read_b128 v[192:195], v248 offset:8192
    ds_read_b128 v[160:163], v244 offset:0
    ds_read_b128 v[164:167], v244 offset:1024
    v_mfma_f32_32x32x16_bf16 v[0:15], v[204:207], v[236:239], v[0:15]
    ds_read_b128 v[196:199], v249 offset:8192
    ds_read_b128 v[168:171], v244 offset:2048
    ds_read_b128 v[172:175], v244 offset:3072
    s_waitcnt lgkmcnt(10)
    v_mfma_f32_32x32x16_bf16 v[16:31], v[208:211], v[224:227], 0
    ds_read_b128 v[200:203], v250 offset:8192
    v_mul_f32 v96, v96, v254
    v_mul_f32 v97, v97, v254
    v_mul_f32 v98, v98, v254
    v_mul_f32 v99, v99, v254
    v_mfma_f32_32x32x16_bf16 v[16:31], v[212:215], v[228:231], v[16:31]
    ds_read_b128 v[204:207], v251 offset:8192
    v_cvt_pk_bf16_f32 v96, v96, v97
    v_cvt_pk_bf16_f32 v97, v98, v99
    ds_write_b64 v243, v[96:97]
    s_waitcnt lgkmcnt(10)
    v_mfma_f32_32x32x16_bf16 v[16:31], v[216:219], v[232:235], v[16:31]
    ds_read_b128 v[208:211], v248 offset:12288
    v_mul_f32 v100, v100, v254
    v_mul_f32 v101, v101, v254
    v_mul_f32 v102, v102, v254
    v_mul_f32 v103, v103, v254
    v_mfma_f32_32x32x16_bf16 v[16:31], v[220:223], v[236:239], v[16:31]
    ds_read_b128 v[212:215], v249 offset:12288
    v_cvt_pk_bf16_f32 v100, v100, v101
    v_cvt_pk_bf16_f32 v101, v102, v103
    v_xor_b32 v102, 16, v243
    ds_write_b64 v102, v[100:101]
    s_waitcnt lgkmcnt(8)
    v_mfma_f32_32x32x16_bf16 v[32:47], v[192:195], v[224:227], 0
    ds_read_b128 v[216:219], v250 offset:12288
    v_mul_f32 v104, v104, v254
    v_mul_f32 v105, v105, v254
    v_mul_f32 v106, v106, v254
    v_mul_f32 v107, v107, v254
    v_mfma_f32_32x32x16_bf16 v[32:47], v[196:199], v[228:231], v[32:47]
    ds_read_b128 v[220:223], v251 offset:12288
    v_cvt_pk_bf16_f32 v104, v104, v105
    v_cvt_pk_bf16_f32 v105, v106, v107
    v_xor_b32 v106, 32, v243
    ds_write_b64 v106, v[104:105]
    s_waitcnt lgkmcnt(7)
    v_mfma_f32_32x32x16_bf16 v[32:47], v[200:203], v[232:235], v[32:47]
    v_mul_f32 v108, v108, v254
    v_mul_f32 v109, v109, v254
    v_mul_f32 v110, v110, v254
    v_mul_f32 v111, v111, v254
    v_mfma_f32_32x32x16_bf16 v[32:47], v[204:207], v[236:239], v[32:47]
    v_cvt_pk_bf16_f32 v108, v108, v109
    v_cvt_pk_bf16_f32 v109, v110, v111
    v_xor_b32 v110, 48, v243
    ds_write_b64 v110, v[108:109]
    s_waitcnt lgkmcnt(5)
    v_mfma_f32_32x32x16_bf16 v[48:63], v[208:211], v[224:227], 0
    v_mul_f32 v112, v112, v254
    v_mul_f32 v113, v113, v254
    v_mul_f32 v114, v114, v254
    v_mul_f32 v115, v115, v254
    v_mfma_f32_32x32x16_bf16 v[48:63], v[212:215], v[228:231], v[48:63]
    s_waitcnt lgkmcnt(2)
    s_waitcnt vmcnt(8)
    s_barrier
    v_add_u32 v248, 114688, v245
    v_xor_b32 v249, 32, v248
    v_xor_b32 v250, 64, v248
    v_xor_b32 v251, 0x60, v248
    ds_read_b128 v[192:195], v248 offset:0
    v_cvt_pk_bf16_f32 v112, v112, v113
    v_cvt_pk_bf16_f32 v113, v114, v115
    ds_read_b128 v[196:199], v249 offset:0
    s_add_u32 m0, s30, 65536
    s_mov_b32 s41, 49280
    buffer_load_dwordx4 v240, s[48:51], s41 offen nt lds
    buffer_load_dwordx4 v241, s[48:51], s41 offen offset:1024 nt lds
    v_xor_b32 v114, 64, v243
    ds_write_b64 v114, v[112:113]
    v_mfma_f32_32x32x16_bf16 v[48:63], v[216:219], v[232:235], v[48:63]
    ds_read_b128 v[200:203], v250 offset:0
    v_mul_f32 v116, v116, v254
    v_mul_f32 v117, v117, v254
    ds_read_b128 v[204:207], v251 offset:0
    s_add_u32 m0, s30, 81920
    s_mov_b32 s41, 49408
    buffer_load_dwordx4 v240, s[48:51], s41 offen nt lds
    buffer_load_dwordx4 v241, s[48:51], s41 offen offset:1024 nt lds
    v_mul_f32 v118, v118, v254
    v_mul_f32 v119, v119, v254
    v_mfma_f32_32x32x16_bf16 v[48:63], v[220:223], v[236:239], v[48:63]
    ds_read_b128 v[208:211], v248 offset:4096
    v_cvt_pk_bf16_f32 v116, v116, v117
    v_cvt_pk_bf16_f32 v117, v118, v119
    ds_read_b128 v[212:215], v249 offset:4096
    v_xor_b32 v118, 80, v243
    ds_write_b64 v118, v[116:117]
    s_waitcnt lgkmcnt(6)
    v_mfma_f32_32x32x16_bf16 v[0:15], v[192:195], v[128:131], v[0:15]
    ds_read_b128 v[216:219], v250 offset:4096
    v_mul_f32 v120, v120, v254
    v_mul_f32 v121, v121, v254
    v_mul_f32 v122, v122, v254
    v_mul_f32 v123, v123, v254
    v_mfma_f32_32x32x16_bf16 v[0:15], v[196:199], v[132:135], v[0:15]
    ds_read_b128 v[220:223], v251 offset:4096
    v_cvt_pk_bf16_f32 v120, v120, v121
    v_cvt_pk_bf16_f32 v121, v122, v123
    v_xor_b32 v122, 96, v243
    ds_write_b64 v122, v[120:121]
    s_waitcnt lgkmcnt(6)
    v_mfma_f32_32x32x16_bf16 v[0:15], v[200:203], v[136:139], v[0:15]
    ds_read_b128 v[192:195], v248 offset:8192
    v_mul_f32 v124, v124, v254
    v_mul_f32 v125, v125, v254
    v_mul_f32 v126, v126, v254
    v_mul_f32 v127, v127, v254
    v_mfma_f32_32x32x16_bf16 v[0:15], v[204:207], v[140:143], v[0:15]
    ds_read_b128 v[196:199], v249 offset:8192
    v_cvt_pk_bf16_f32 v124, v124, v125
    v_cvt_pk_bf16_f32 v125, v126, v127
    v_xor_b32 v126, 112, v243
    ds_write_b64 v126, v[124:125]
    s_waitcnt lgkmcnt(7)
    v_mfma_f32_32x32x16_bf16 v[16:31], v[208:211], v[128:131], v[16:31]
    ds_read_b128 v[200:203], v250 offset:8192
    v_mfma_f32_32x32x16_bf16 v[16:31], v[212:215], v[132:135], v[16:31]
    ds_read_b128 v[204:207], v251 offset:8192
    s_waitcnt lgkmcnt(6)
    v_mfma_f32_32x32x16_bf16 v[16:31], v[216:219], v[136:139], v[16:31]
    ds_read_b128 v[208:211], v248 offset:12288
    v_mfma_f32_32x32x16_bf16 v[16:31], v[220:223], v[140:143], v[16:31]
    ds_read_b128 v[212:215], v249 offset:12288
    s_waitcnt lgkmcnt(5)
    v_mfma_f32_32x32x16_bf16 v[32:47], v[192:195], v[128:131], v[32:47]
    ds_read_b128 v[216:219], v250 offset:12288
    v_mfma_f32_32x32x16_bf16 v[32:47], v[196:199], v[132:135], v[32:47]
    ds_read_b128 v[220:223], v251 offset:12288
    s_waitcnt lgkmcnt(4)
    v_mfma_f32_32x32x16_bf16 v[32:47], v[200:203], v[136:139], v[32:47]
    v_mfma_f32_32x32x16_bf16 v[32:47], v[204:207], v[140:143], v[32:47]
    s_waitcnt lgkmcnt(2)
    v_mfma_f32_32x32x16_bf16 v[48:63], v[208:211], v[128:131], v[48:63]
    v_mfma_f32_32x32x16_bf16 v[48:63], v[212:215], v[132:135], v[48:63]
    s_waitcnt lgkmcnt(0)
    s_waitcnt vmcnt(6)
    s_barrier
    s_mov_b32 s40, s31
    v_add_u32 v248, s40, v245
    v_xor_b32 v249, 32, v248
    v_xor_b32 v250, 64, v248
    v_xor_b32 v251, 0x60, v248
    ds_read_b128 v[144:147], v248
    ds_read_b128 v[148:151], v249
    ds_read_b128 v[152:155], v250
    ds_read_b128 v[156:159], v251
    v_add_u32 v248, 32768, v245
    v_xor_b32 v249, 32, v248
    v_xor_b32 v250, 64, v248
    v_xor_b32 v251, 0x60, v248
    ds_read_b128 v[192:195], v248 offset:0
    ds_read_b128 v[196:199], v249 offset:0
    s_add_u32 m0, s30, 98304
    s_nop 0
    buffer_load_dwordx4 v240, s[52:55], 0 offen nt lds
    buffer_load_dwordx4 v241, s[52:55], 0 offen offset:1024 nt lds
    v_mfma_f32_32x32x16_bf16 v[48:63], v[216:219], v[136:139], v[48:63]
    ds_read_b128 v[200:203], v250 offset:0
    ds_read_b128 v[204:207], v251 offset:0
    v_mfma_f32_32x32x16_bf16 v[48:63], v[220:223], v[140:143], v[48:63]
    ds_read_b128 v[208:211], v248 offset:4096
    ds_read_b128 v[212:215], v249 offset:4096
    s_waitcnt lgkmcnt(4)
    v_mfma_f32_32x32x16_bf16 v[0:15], v[192:195], v[144:147], v[0:15]
    ds_read_b128 v[216:219], v250 offset:4096
    v_mfma_f32_32x32x16_bf16 v[0:15], v[196:199], v[148:151], v[0:15]
    ds_read_b128 v[220:223], v251 offset:4096
    s_waitcnt lgkmcnt(4)
    v_mfma_f32_32x32x16_bf16 v[0:15], v[200:203], v[152:155], v[0:15]
    ds_read_b128 v[192:195], v248 offset:8192
    v_mfma_f32_32x32x16_bf16 v[0:15], v[204:207], v[156:159], v[0:15]
    ds_read_b128 v[196:199], v249 offset:8192
    s_waitcnt lgkmcnt(4)
    v_mfma_f32_32x32x16_bf16 v[16:31], v[208:211], v[144:147], v[16:31]
    ds_read_b128 v[200:203], v250 offset:8192
    v_mfma_f32_32x32x16_bf16 v[16:31], v[212:215], v[148:151], v[16:31]
    ds_read_b128 v[204:207], v251 offset:8192
    s_waitcnt lgkmcnt(4)
    v_mfma_f32_32x32x16_bf16 v[16:31], v[216:219], v[152:155], v[16:31]
    ds_read_b128 v[208:211], v248 offset:12288
    v_mfma_f32_32x32x16_bf16 v[16:31], v[220:223], v[156:159], v[16:31]
    ds_read_b128 v[212:215], v249 offset:12288
    s_waitcnt lgkmcnt(4)
    v_mfma_f32_32x32x16_bf16 v[32:47], v[192:195], v[144:147], v[32:47]
    ds_read_b128 v[216:219], v250 offset:12288
    v_max3_f32 v176, v0, v1, v2
    v_max3_f32 v177, v3, v4, v5
    v_max3_f32 v178, v6, v7, v8
    v_max3_f32 v179, v9, v10, v11
    v_max3_f32 v176, v176, v12, v13
    v_max3_f32 v177, v177, v14, v15
    v_mfma_f32_32x32x16_bf16 v[32:47], v[196:199], v[148:151], v[32:47]
    ds_read_b128 v[220:223], v251 offset:12288
    s_waitcnt lgkmcnt(4)
    v_mfma_f32_32x32x16_bf16 v[32:47], v[200:203], v[152:155], v[32:47]
    v_mfma_f32_32x32x16_bf16 v[32:47], v[204:207], v[156:159], v[32:47]
    s_waitcnt lgkmcnt(2)
    v_mfma_f32_32x32x16_bf16 v[48:63], v[208:211], v[144:147], v[48:63]
    buffer_store_dwordx4 v[64:67], v242, s[24:27], s36 offen sc0 sc1
    v_max3_f32 v178, v178, v16, v17
    v_max3_f32 v179, v179, v18, v19
    v_max3_f32 v176, v176, v20, v21
    v_max3_f32 v177, v177, v22, v23
    v_max3_f32 v178, v178, v24, v25
    v_max3_f32 v179, v179, v26, v27
    v_max3_f32 v176, v176, v28, v29
    v_max3_f32 v177, v177, v30, v31
    v_mfma_f32_32x32x16_bf16 v[48:63], v[212:215], v[148:151], v[48:63]
    s_waitcnt lgkmcnt(0)
    s_waitcnt vmcnt(7)
    s_barrier
    v_add_u32 v248, 49152, v245
    v_xor_b32 v249, 32, v248
    v_xor_b32 v250, 64, v248
    v_xor_b32 v251, 0x60, v248
    ds_read_b128 v[192:195], v248 offset:0
    s_add_u32 m0, s30, 114688
    s_mov_b32 s41, 128
    buffer_load_dwordx4 v240, s[52:55], s41 offen nt lds
    buffer_load_dwordx4 v241, s[52:55], s41 offen offset:1024 nt lds
    ds_read_b128 v[196:199], v249 offset:0
    buffer_store_dwordx4 v[68:71], v242, s[24:27], s37 offen sc0 sc1
    v_mfma_f32_32x32x16_bf16 v[48:63], v[216:219], v[152:155], v[48:63]
    ds_read_b128 v[200:203], v250 offset:0
    ds_read_b128 v[204:207], v251 offset:0
    buffer_store_dwordx4 v[72:75], v242, s[24:27], s38 offen sc0 sc1
    v_mfma_f32_32x32x16_bf16 v[48:63], v[220:223], v[156:159], v[48:63]
    ds_read_b128 v[208:211], v248 offset:4096
    ds_read_b128 v[212:215], v249 offset:4096
    buffer_store_dwordx4 v[76:79], v242, s[24:27], s39 offen sc0 sc1
    s_waitcnt lgkmcnt(4)
    v_mfma_f32_32x32x16_bf16 v[64:79], v[192:195], v[224:227], 0
    ds_read_b128 v[216:219], v250 offset:4096
    v_max3_f32 v178, v178, v32, v33
    v_max3_f32 v179, v179, v34, v35
    v_max3_f32 v176, v176, v36, v37
    v_max3_f32 v177, v177, v38, v39
    v_max3_f32 v178, v178, v40, v41
    v_max3_f32 v179, v179, v42, v43
    v_max3_f32 v176, v176, v44, v45
    v_max3_f32 v177, v177, v46, v47
    v_mfma_f32_32x32x16_bf16 v[64:79], v[196:199], v[228:231], v[64:79]
    ds_read_b128 v[220:223], v251 offset:4096
    s_waitcnt lgkmcnt(4)
    v_mfma_f32_32x32x16_bf16 v[64:79], v[200:203], v[232:235], v[64:79]
    ds_read_b128 v[192:195], v248 offset:8192
    v_mfma_f32_32x32x16_bf16 v[64:79], v[204:207], v[236:239], v[64:79]
    ds_read_b128 v[196:199], v249 offset:8192
    s_waitcnt lgkmcnt(4)
    v_mfma_f32_32x32x16_bf16 v[80:95], v[208:211], v[224:227], 0
    ds_read_b128 v[200:203], v250 offset:8192
    v_max3_f32 v178, v178, v48, v49
    v_max3_f32 v179, v179, v50, v51
    v_max3_f32 v176, v176, v52, v53
    v_max3_f32 v177, v177, v54, v55
    v_max3_f32 v178, v178, v56, v57
    v_max3_f32 v179, v179, v58, v59
    v_max3_f32 v176, v176, v60, v61
    v_max3_f32 v177, v177, v62, v63
    v_max3_f32 v176, v176, v177, v178
    v_max_f32 v180, v176, v179
    v_max_f32 v181, v176, v179
    v_mov_b32 v182, 0
    v_mov_b32 v183, 0
    v_mov_b32 v184, 0
    v_mov_b32 v185, 0
    v_permlane32_swap_b32 v180, v181
    s_nop 0
    v_max_f32 v252, v180, v181
    v_mul_f32 v254, s42, v252
    v_fma_f32 v0, v0, s32, v254
    v_fma_f32 v1, v1, s32, v254
    v_fma_f32 v2, v2, s32, v254
    v_fma_f32 v3, v3, s32, v254
    v_exp_f32 v0, v0
    v_exp_f32 v1, v1
    v_fma_f32 v4, v4, s32, v254
    v_fma_f32 v5, v5, s32, v254
    v_exp_f32 v2, v2
    v_exp_f32 v3, v3
    v_add_f32 v182, v182, v0
    v_add_f32 v183, v183, v1
    v_cvt_pk_bf16_f32 v0, v0, v1
    v_fma_f32 v6, v6, s32, v254
    v_fma_f32 v7, v7, s32, v254
    v_exp_f32 v4, v4
    v_exp_f32 v5, v5
    v_add_f32 v184, v184, v2
    v_add_f32 v185, v185, v3
    v_cvt_pk_bf16_f32 v1, v2, v3
    v_fma_f32 v8, v8, s32, v254
    v_fma_f32 v9, v9, s32, v254
    v_exp_f32 v6, v6
    v_exp_f32 v7, v7
    v_add_f32 v182, v182, v4
    v_add_f32 v183, v183, v5
    v_cvt_pk_bf16_f32 v2, v4, v5
    v_fma_f32 v10, v10, s32, v254
    v_fma_f32 v11, v11, s32, v254
    v_exp_f32 v8, v8
    v_exp_f32 v9, v9
    v_add_f32 v184, v184, v6
    v_add_f32 v185, v185, v7
    v_cvt_pk_bf16_f32 v3, v6, v7
    v_mfma_f32_32x32x16_bf16 v[80:95], v[212:215], v[228:231], v[80:95]
    ds_read_b128 v[204:207], v251 offset:8192
    v_fma_f32 v12, v12, s32, v254
    v_fma_f32 v13, v13, s32, v254
    v_exp_f32 v10, v10
    v_exp_f32 v11, v11
    s_waitcnt lgkmcnt(4)
    v_mfma_f32_32x32x16_bf16 v[80:95], v[216:219], v[232:235], v[80:95]
    ds_read_b128 v[208:211], v248 offset:12288
    v_add_f32 v182, v182, v8
    v_add_f32 v183, v183, v9
    v_cvt_pk_bf16_f32 v4, v8, v9
    v_fma_f32 v14, v14, s32, v254
    v_fma_f32 v15, v15, s32, v254
    v_mfma_f32_32x32x16_bf16 v[80:95], v[220:223], v[236:239], v[80:95]
    ds_read_b128 v[212:215], v249 offset:12288
    v_exp_f32 v12, v12
    v_exp_f32 v13, v13
    v_add_f32 v184, v184, v10
    v_add_f32 v185, v185, v11
    s_waitcnt lgkmcnt(4)
    v_mfma_f32_32x32x16_bf16 v[96:111], v[192:195], v[224:227], 0
    ds_read_b128 v[216:219], v250 offset:12288
    v_cvt_pk_bf16_f32 v5, v10, v11
    v_fma_f32 v16, v16, s32, v254
    v_fma_f32 v17, v17, s32, v254
    v_exp_f32 v14, v14
    v_exp_f32 v15, v15
    v_mfma_f32_32x32x16_bf16 v[96:111], v[196:199], v[228:231], v[96:111]
    ds_read_b128 v[220:223], v251 offset:12288
    v_add_f32 v182, v182, v12
    v_add_f32 v183, v183, v13
    v_cvt_pk_bf16_f32 v6, v12, v13
    v_fma_f32 v18, v18, s32, v254
    s_waitcnt lgkmcnt(4)
    v_mfma_f32_32x32x16_bf16 v[96:111], v[200:203], v[232:235], v[96:111]
    v_fma_f32 v19, v19, s32, v254
    v_exp_f32 v16, v16
    v_exp_f32 v17, v17
    v_add_f32 v184, v184, v14
    v_mfma_f32_32x32x16_bf16 v[96:111], v[204:207], v[236:239], v[96:111]
    v_add_f32 v185, v185, v15
    v_cvt_pk_bf16_f32 v7, v14, v15
    v_fma_f32 v20, v20, s32, v254
    v_fma_f32 v21, v21, s32, v254
    v_exp_f32 v18, v18
    s_waitcnt lgkmcnt(2)
    v_mfma_f32_32x32x16_bf16 v[112:127], v[208:211], v[224:227], 0
    v_exp_f32 v19, v19
    v_add_f32 v182, v182, v16
    v_add_f32 v183, v183, v17
    v_cvt_pk_bf16_f32 v8, v16, v17
    v_mfma_f32_32x32x16_bf16 v[112:127], v[212:215], v[228:231], v[112:127]
    s_waitcnt lgkmcnt(0)
    s_waitcnt vmcnt(10)
    s_barrier
    v_add_u32 v248, 65536, v245
    v_xor_b32 v249, 32, v248
    v_xor_b32 v250, 64, v248
    v_xor_b32 v251, 0x60, v248
    ds_read_b128 v[192:195], v248 offset:0
    v_fma_f32 v22, v22, s32, v254
    v_fma_f32 v23, v23, s32, v254
    ds_read_b128 v[196:199], v249 offset:0
    s_mov_b32 m0, s30
    s_mov_b32 s41, 256
    buffer_load_dwordx4 v240, s[52:55], s41 offen nt lds
    buffer_load_dwordx4 v241, s[52:55], s41 offen offset:1024 nt lds
    v_exp_f32 v20, v20
    v_exp_f32 v21, v21
    v_mfma_f32_32x32x16_bf16 v[112:127], v[216:219], v[232:235], v[112:127]
    ds_read_b128 v[200:203], v250 offset:0
    v_add_f32 v184, v184, v18
    v_add_f32 v185, v185, v19
    ds_read_b128 v[204:207], v251 offset:0
    v_cvt_pk_bf16_f32 v9, v18, v19
    v_fma_f32 v24, v24, s32, v254
    v_fma_f32 v25, v25, s32, v254
    v_mfma_f32_32x32x16_bf16 v[112:127], v[220:223], v[236:239], v[112:127]
    ds_read_b128 v[208:211], v248 offset:4096
    v_exp_f32 v22, v22
    v_exp_f32 v23, v23
    ds_read_b128 v[212:215], v249 offset:4096
    v_add_f32 v182, v182, v20
    v_add_f32 v183, v183, v21
    s_waitcnt lgkmcnt(4)
    v_mfma_f32_32x32x16_bf16 v[64:79], v[192:195], v[128:131], v[64:79]
    ds_read_b128 v[216:219], v250 offset:4096
    v_cvt_pk_bf16_f32 v10, v20, v21
    v_fma_f32 v26, v26, s32, v254
    v_fma_f32 v27, v27, s32, v254
    v_exp_f32 v24, v24
    v_exp_f32 v25, v25
    v_mfma_f32_32x32x16_bf16 v[64:79], v[196:199], v[132:135], v[64:79]
    ds_read_b128 v[220:223], v251 offset:4096
    v_add_f32 v184, v184, v22
    v_add_f32 v185, v185, v23
    v_cvt_pk_bf16_f32 v11, v22, v23
    v_fma_f32 v28, v28, s32, v254
    s_waitcnt lgkmcnt(4)
    v_mfma_f32_32x32x16_bf16 v[64:79], v[200:203], v[136:139], v[64:79]
    ds_read_b128 v[192:195], v248 offset:8192
    v_fma_f32 v29, v29, s32, v254
    v_exp_f32 v26, v26
    v_exp_f32 v27, v27
    v_add_f32 v182, v182, v24
    v_mfma_f32_32x32x16_bf16 v[64:79], v[204:207], v[140:143], v[64:79]
    ds_read_b128 v[196:199], v249 offset:8192
    v_add_f32 v183, v183, v25
    v_cvt_pk_bf16_f32 v12, v24, v25
    v_fma_f32 v30, v30, s32, v254
    v_fma_f32 v31, v31, s32, v254
    v_exp_f32 v28, v28
    s_waitcnt lgkmcnt(4)
    v_mfma_f32_32x32x16_bf16 v[80:95], v[208:211], v[128:131], v[80:95]
    ds_read_b128 v[200:203], v250 offset:8192
    v_exp_f32 v29, v29
    v_add_f32 v184, v184, v26
    v_add_f32 v185, v185, v27
    v_cvt_pk_bf16_f32 v13, v26, v27
    v_mfma_f32_32x32x16_bf16 v[80:95], v[212:215], v[132:135], v[80:95]
    ds_read_b128 v[204:207], v251 offset:8192
    v_fma_f32 v32, v32, s32, v254
    v_fma_f32 v33, v33, s32, v254
    v_exp_f32 v30, v30
    v_exp_f32 v31, v31
    s_waitcnt lgkmcnt(4)
    v_mfma_f32_32x32x16_bf16 v[80:95], v[216:219], v[136:139], v[80:95]
    ds_read_b128 v[208:211], v248 offset:12288
    v_add_f32 v182, v182, v28
    v_add_f32 v183, v183, v29
    v_cvt_pk_bf16_f32 v14, v28, v29
    v_fma_f32 v34, v34, s32, v254
    v_fma_f32 v35, v35, s32, v254
    v_mfma_f32_32x32x16_bf16 v[80:95], v[220:223], v[140:143], v[80:95]
    ds_read_b128 v[212:215], v249 offset:12288
    v_exp_f32 v32, v32
    v_exp_f32 v33, v33
    v_add_f32 v184, v184, v30
    v_add_f32 v185, v185, v31
    s_waitcnt lgkmcnt(4)
    v_mfma_f32_32x32x16_bf16 v[96:111], v[192:195], v[128:131], v[96:111]
    ds_read_b128 v[216:219], v250 offset:12288
    v_cvt_pk_bf16_f32 v15, v30, v31
    v_fma_f32 v36, v36, s32, v254
    v_fma_f32 v37, v37, s32, v254
    v_exp_f32 v34, v34
    v_exp_f32 v35, v35
    v_mfma_f32_32x32x16_bf16 v[96:111], v[196:199], v[132:135], v[96:111]
    ds_read_b128 v[220:223], v251 offset:12288
    v_add_f32 v182, v182, v32
    v_add_f32 v183, v183, v33
    v_cvt_pk_bf16_f32 v16, v32, v33
    v_fma_f32 v38, v38, s32, v254
    s_waitcnt lgkmcnt(4)
    v_mfma_f32_32x32x16_bf16 v[96:111], v[200:203], v[136:139], v[96:111]
    v_fma_f32 v39, v39, s32, v254
    v_exp_f32 v36, v36
    v_exp_f32 v37, v37
    v_add_f32 v184, v184, v34
    v_mfma_f32_32x32x16_bf16 v[96:111], v[204:207], v[140:143], v[96:111]
    v_add_f32 v185, v185, v35
    v_cvt_pk_bf16_f32 v17, v34, v35
    v_fma_f32 v40, v40, s32, v254
    v_fma_f32 v41, v41, s32, v254
    v_exp_f32 v38, v38
    s_waitcnt lgkmcnt(2)
    v_mfma_f32_32x32x16_bf16 v[112:127], v[208:211], v[128:131], v[112:127]
    v_exp_f32 v39, v39
    v_add_f32 v182, v182, v36
    v_add_f32 v183, v183, v37
    v_cvt_pk_bf16_f32 v18, v36, v37
    v_mfma_f32_32x32x16_bf16 v[112:127], v[212:215], v[132:135], v[112:127]
    s_waitcnt lgkmcnt(0)
    s_waitcnt vmcnt(10)
    s_barrier
    v_add_u32 v248, 81920, v245
    v_xor_b32 v249, 32, v248
    v_xor_b32 v250, 64, v248
    v_xor_b32 v251, 0x60, v248
    ds_read_b128 v[192:195], v248 offset:0
    v_fma_f32 v42, v42, s32, v254
    v_fma_f32 v43, v43, s32, v254
    ds_read_b128 v[196:199], v249 offset:0
    s_add_u32 m0, s30, 16384
    s_mov_b32 s41, 49152
    buffer_load_dwordx4 v240, s[52:55], s41 offen nt lds
    buffer_load_dwordx4 v241, s[52:55], s41 offen offset:1024 nt lds
    v_exp_f32 v40, v40
    v_exp_f32 v41, v41
    v_mfma_f32_32x32x16_bf16 v[112:127], v[216:219], v[136:139], v[112:127]
    ds_read_b128 v[200:203], v250 offset:0
    v_add_f32 v184, v184, v38
    v_add_f32 v185, v185, v39
    v_cvt_pk_bf16_f32 v19, v38, v39
    ds_read_b128 v[204:207], v251 offset:0
    v_fma_f32 v44, v44, s32, v254
    v_fma_f32 v45, v45, s32, v254
    v_exp_f32 v42, v42
    v_mfma_f32_32x32x16_bf16 v[112:127], v[220:223], v[140:143], v[112:127]
    ds_read_b128 v[208:211], v248 offset:4096
    v_exp_f32 v43, v43
    ds_read_b128 v[212:215], v249 offset:4096
    v_add_f32 v182, v182, v40
    v_add_f32 v183, v183, v41
    s_waitcnt lgkmcnt(4)
    v_mfma_f32_32x32x16_bf16 v[64:79], v[192:195], v[144:147], v[64:79]
    ds_read_b128 v[216:219], v250 offset:4096
    v_cvt_pk_bf16_f32 v20, v40, v41
    v_fma_f32 v46, v46, s32, v254
    v_fma_f32 v47, v47, s32, v254
    v_exp_f32 v44, v44
    v_exp_f32 v45, v45
    v_mfma_f32_32x32x16_bf16 v[64:79], v[196:199], v[148:151], v[64:79]
    ds_read_b128 v[220:223], v251 offset:4096
    v_add_f32 v184, v184, v42
    v_add_f32 v185, v185, v43
    v_cvt_pk_bf16_f32 v21, v42, v43
    v_fma_f32 v48, v48, s32, v254
    s_waitcnt lgkmcnt(4)
    v_mfma_f32_32x32x16_bf16 v[64:79], v[200:203], v[152:155], v[64:79]
    ds_read_b128 v[192:195], v248 offset:8192
    v_fma_f32 v49, v49, s32, v254
    v_exp_f32 v46, v46
    v_exp_f32 v47, v47
    v_add_f32 v182, v182, v44
    v_mfma_f32_32x32x16_bf16 v[64:79], v[204:207], v[156:159], v[64:79]
    ds_read_b128 v[196:199], v249 offset:8192
    v_add_f32 v183, v183, v45
    v_cvt_pk_bf16_f32 v22, v44, v45
    v_fma_f32 v50, v50, s32, v254
    v_fma_f32 v51, v51, s32, v254
    v_exp_f32 v48, v48
    s_waitcnt lgkmcnt(4)
    v_mfma_f32_32x32x16_bf16 v[80:95], v[208:211], v[144:147], v[80:95]
    ds_read_b128 v[200:203], v250 offset:8192
    v_exp_f32 v49, v49
    v_add_f32 v184, v184, v46
    v_add_f32 v185, v185, v47
    v_cvt_pk_bf16_f32 v23, v46, v47
    v_mfma_f32_32x32x16_bf16 v[80:95], v[212:215], v[148:151], v[80:95]
    ds_read_b128 v[204:207], v251 offset:8192
    v_fma_f32 v52, v52, s32, v254
    v_fma_f32 v53, v53, s32, v254
    v_exp_f32 v50, v50
    v_exp_f32 v51, v51
    s_waitcnt lgkmcnt(4)
    v_mfma_f32_32x32x16_bf16 v[80:95], v[216:219], v[152:155], v[80:95]
    ds_read_b128 v[208:211], v248 offset:12288
    v_add_f32 v182, v182, v48
    v_add_f32 v183, v183, v49
    v_cvt_pk_bf16_f32 v24, v48, v49
    v_fma_f32 v54, v54, s32, v254
    v_fma_f32 v55, v55, s32, v254
    v_exp_f32 v52, v52
    v_mfma_f32_32x32x16_bf16 v[80:95], v[220:223], v[156:159], v[80:95]
    ds_read_b128 v[212:215], v249 offset:12288
    v_exp_f32 v53, v53
    v_add_f32 v184, v184, v50
    v_add_f32 v185, v185, v51
    s_waitcnt lgkmcnt(4)
    v_mfma_f32_32x32x16_bf16 v[96:111], v[192:195], v[144:147], v[96:111]
    ds_read_b128 v[216:219], v250 offset:12288
    v_cvt_pk_bf16_f32 v25, v50, v51
    v_fma_f32 v56, v56, s32, v254
    v_fma_f32 v57, v57, s32, v254
    v_exp_f32 v54, v54
    v_exp_f32 v55, v55
    v_mfma_f32_32x32x16_bf16 v[96:111], v[196:199], v[148:151], v[96:111]
    ds_read_b128 v[220:223], v251 offset:12288
    v_add_f32 v182, v182, v52
    v_add_f32 v183, v183, v53
    v_cvt_pk_bf16_f32 v26, v52, v53
    v_fma_f32 v58, v58, s32, v254
    v_fma_f32 v59, v59, s32, v254
    s_waitcnt lgkmcnt(4)
    v_mfma_f32_32x32x16_bf16 v[96:111], v[200:203], v[152:155], v[96:111]
    v_exp_f32 v56, v56
    v_exp_f32 v57, v57
    v_add_f32 v184, v184, v54
    v_mfma_f32_32x32x16_bf16 v[96:111], v[204:207], v[156:159], v[96:111]
    v_add_f32 v185, v185, v55
    v_cvt_pk_bf16_f32 v27, v54, v55
    v_fma_f32 v60, v60, s32, v254
    v_fma_f32 v61, v61, s32, v254
    v_exp_f32 v58, v58
    s_waitcnt lgkmcnt(2)
    v_mfma_f32_32x32x16_bf16 v[112:127], v[208:211], v[144:147], v[112:127]
    buffer_store_dwordx4 v[160:163], v242, s[24:27], s36 offen offset:128 sc0 sc1
    v_exp_f32 v59, v59
    v_add_f32 v182, v182, v56
    v_add_f32 v183, v183, v57
    v_cvt_pk_bf16_f32 v28, v56, v57
    v_mfma_f32_32x32x16_bf16 v[112:127], v[212:215], v[148:151], v[112:127]
    s_waitcnt lgkmcnt(0)
    s_waitcnt vmcnt(11)
    s_barrier
    v_add_u32 v248, 98304, v246
    v_xor_b32 v249, 32, v248
    v_xor_b32 v250, 64, v248
    v_xor_b32 v251, 0x60, v248
    ds_read_b64_tr_b16 v[192:193], v248 offset:0
    buffer_store_dwordx4 v[164:167], v242, s[24:27], s37 offen offset:128 sc0 sc1
    ds_read_b64_tr_b16 v[194:195], v249 offset:1024
    v_fma_f32 v62, v62, s32, v254
    s_add_u32 m0, s30, 32768
    s_mov_b32 s41, 49280
    buffer_load_dwordx4 v240, s[52:55], s41 offen nt lds
    buffer_load_dwordx4 v241, s[52:55], s41 offen offset:1024 nt lds
    ds_read_b64_tr_b16 v[196:197], v250 offset:0
    v_fma_f32 v63, v63, s32, v254
    ds_read_b64_tr_b16 v[198:199], v251 offset:1024
    v_exp_f32 v60, v60
    v_exp_f32 v61, v61
    v_mfma_f32_32x32x16_bf16 v[112:127], v[216:219], v[152:155], v[112:127]
    ds_read_b64_tr_b16 v[200:201], v248 offset:2048
    buffer_store_dwordx4 v[168:171], v242, s[24:27], s38 offen offset:128 sc0 sc1
    ds_read_b64_tr_b16 v[202:203], v249 offset:3072
    v_add_f32 v184, v184, v58
    v_add_f32 v185, v185, v59
    ds_read_b64_tr_b16 v[204:205], v250 offset:2048
    v_cvt_pk_bf16_f32 v29, v58, v59
    ds_read_b64_tr_b16 v[206:207], v251 offset:3072
    v_exp_f32 v62, v62
    v_exp_f32 v63, v63
    v_mfma_f32_32x32x16_bf16 v[112:127], v[220:223], v[156:159], v[112:127]
    ds_read_b64_tr_b16 v[208:209], v248 offset:4096
    buffer_store_dwordx4 v[172:175], v242, s[24:27], s39 offen offset:128 sc0 sc1
    ds_read_b64_tr_b16 v[210:211], v249 offset:5120
    v_add_f32 v182, v182, v60
    v_add_f32 v183, v183, v61
    ds_read_b64_tr_b16 v[212:213], v250 offset:4096
    v_cvt_pk_bf16_f32 v30, v60, v61
    ds_read_b64_tr_b16 v[214:215], v251 offset:5120
    s_nop 0
    v_add_f32 v184, v184, v62
    s_waitcnt lgkmcnt(8)
    v_mfma_f32_32x32x16_bf16 v[128:143], v[192:195], v[0:3], 0
    ds_read_b64_tr_b16 v[216:217], v248 offset:6144
    v_add_f32 v185, v185, v63
    v_cvt_pk_bf16_f32 v31, v62, v63
    ds_read_b64_tr_b16 v[218:219], v249 offset:7168
    v_add_f32 v182, v182, v184
    v_add_f32 v183, v183, v185
    v_add_f32 v247, v182, v183
    v_mfma_f32_32x32x16_bf16 v[144:159], v[196:199], v[0:3], 0
    ds_read_b64_tr_b16 v[220:221], v250 offset:6144
    v_max3_f32 v224, v64, v65, v66
    v_max3_f32 v225, v67, v68, v69
    v_max3_f32 v226, v70, v71, v72
    ds_read_b64_tr_b16 v[222:223], v251 offset:7168
    v_max3_f32 v227, v73, v74, v75
    v_max3_f32 v224, v224, v76, v77
    v_max3_f32 v225, v225, v78, v79
    v_max3_f32 v226, v226, v80, v81
    s_waitcnt lgkmcnt(8)
    v_mfma_f32_32x32x16_bf16 v[128:143], v[200:203], v[4:7], v[128:143]
    ds_read_b64_tr_b16 v[192:193], v248 offset:8192
    v_max3_f32 v227, v227, v82, v83
    v_max3_f32 v224, v224, v84, v85
    v_max3_f32 v225, v225, v86, v87
    ds_read_b64_tr_b16 v[194:195], v249 offset:9216
    v_max3_f32 v226, v226, v88, v89
    v_max3_f32 v227, v227, v90, v91
    v_max3_f32 v224, v224, v92, v93
    v_max3_f32 v225, v225, v94, v95
    v_mfma_f32_32x32x16_bf16 v[144:159], v[204:207], v[4:7], v[144:159]
    ds_read_b64_tr_b16 v[196:197], v250 offset:8192
    ds_read_b128 v[176:179], v244 offset:0
    ds_read_b128 v[180:183], v244 offset:1024
    v_max3_f32 v226, v226, v96, v97
    v_max3_f32 v227, v227, v98, v99
    ds_read_b64_tr_b16 v[198:199], v251 offset:9216
    v_max3_f32 v224, v224, v100, v101
    v_max3_f32 v225, v225, v102, v103
    v_max3_f32 v226, v226, v104, v105
    v_max3_f32 v227, v227, v106, v107
    s_waitcnt lgkmcnt(10)
    v_mfma_f32_32x32x16_bf16 v[128:143], v[208:211], v[8:11], v[128:143]
    ds_read_b64_tr_b16 v[200:201], v248 offset:10240
    ds_read_b128 v[184:187], v244 offset:2048
    ds_read_b128 v[188:191], v244 offset:3072
    v_max3_f32 v224, v224, v108, v109
    v_max3_f32 v225, v225, v110, v111
    ds_read_b64_tr_b16 v[202:203], v249 offset:11264
    v_max3_f32 v226, v226, v112, v113
    v_max3_f32 v227, v227, v114, v115
    v_max3_f32 v224, v224, v116, v117
    v_max3_f32 v225, v225, v118, v119
    v_max3_f32 v226, v226, v120, v121
    v_mfma_f32_32x32x16_bf16 v[144:159], v[212:215], v[8:11], v[144:159]
    ds_read_b64_tr_b16 v[204:205], v250 offset:10240
    s_waitcnt lgkmcnt(7)
    buffer_store_dwordx4 v[176:179], v242, s[24:27], s36 offen offset:256 sc0 sc1
    v_max3_f32 v227, v227, v122, v123
    v_max3_f32 v224, v224, v124, v125
    v_max3_f32 v225, v225, v126, v127
    ds_read_b64_tr_b16 v[206:207], v251 offset:11264
    v_max3_f32 v224, v224, v225, v226
    v_max_f32 v228, v224, v227
    v_max_f32 v229, v224, v227
    v_mov_b32 v230, 0
    v_mfma_f32_32x32x16_bf16 v[128:143], v[216:219], v[12:15], v[128:143]
    ds_read_b64_tr_b16 v[208:209], v248 offset:12288
    s_waitcnt lgkmcnt(8)
    buffer_store_dwordx4 v[180:183], v242, s[24:27], s37 offen offset:256 sc0 sc1
    v_mov_b32 v231, 0
    v_mov_b32 v232, 0
    v_mov_b32 v233, 0
    ds_read_b64_tr_b16 v[210:211], v249 offset:13312
    v_permlane32_swap_b32 v228, v229
    s_nop 0
    v_max3_f32 v228, v228, v229, v252
    v_sub_f32 v229, v228, v252
    v_mfma_f32_32x32x16_bf16 v[144:159], v[220:223], v[12:15], v[144:159]
    ds_read_b64_tr_b16 v[212:213], v250 offset:12288
    s_waitcnt lgkmcnt(7)
    buffer_store_dwordx4 v[184:187], v242, s[24:27], s38 offen offset:256 sc0 sc1
    v_cmp_lt_f32 s[80:81], s43, v229
    s_nop 3
    s_cmp_lg_u64 s[80:81], 0
    s_cselect_b32 s33, 1, 0
    s_cselect_b64 s[80:81], -1, 0
    s_nop 1
    v_cndmask_b32 v228, v252, v228, s[80:81]
    ds_read_b64_tr_b16 v[214:215], v251 offset:13312
    v_mul_f32 v254, s42, v228
    v_fma_f32 v229, v252, s32, v254
    v_mfma_f32_32x32x16_bf16 v[128:143], v[192:195], v[16:19], v[128:143]
    ds_read_b64_tr_b16 v[216:217], v248 offset:14336
    s_waitcnt lgkmcnt(8)
    buffer_store_dwordx4 v[188:191], v242, s[24:27], s39 offen offset:256 sc0 sc1
    v_exp_f32 v252, v229
    v_fma_f32 v112, v112, s32, v254
    ds_read_b64_tr_b16 v[218:219], v249 offset:15360
    v_fma_f32 v113, v113, s32, v254
    v_fma_f32 v114, v114, s32, v254
    v_fma_f32 v115, v115, s32, v254
    v_mfma_f32_32x32x16_bf16 v[144:159], v[196:199], v[16:19], v[144:159]
    ds_read_b64_tr_b16 v[220:221], v250 offset:14336
    v_exp_f32 v112, v112
    v_exp_f32 v113, v113
    ds_read_b64_tr_b16 v[222:223], v251 offset:15360
    v_fma_f32 v116, v116, s32, v254
    v_fma_f32 v117, v117, s32, v254
    v_exp_f32 v114, v114
    s_waitcnt lgkmcnt(8)
    v_mfma_f32_32x32x16_bf16 v[128:143], v[200:203], v[20:23], v[128:143]
    v_exp_f32 v115, v115
    v_add_f32 v230, v230, v112
    v_add_f32 v231, v231, v113
    v_cvt_pk_bf16_f32 v56, v112, v113
    v_fma_f32 v118, v118, s32, v254
    v_mfma_f32_32x32x16_bf16 v[144:159], v[204:207], v[20:23], v[144:159]
    v_fma_f32 v119, v119, s32, v254
    v_exp_f32 v116, v116
    v_exp_f32 v117, v117
    v_add_f32 v232, v232, v114
    v_add_f32 v233, v233, v115
    s_waitcnt lgkmcnt(4)
    v_mfma_f32_32x32x16_bf16 v[128:143], v[208:211], v[24:27], v[128:143]
    v_cvt_pk_bf16_f32 v57, v114, v115
    v_fma_f32 v120, v120, s32, v254
    v_fma_f32 v121, v121, s32, v254
    v_exp_f32 v118, v118
    v_exp_f32 v119, v119
    v_mfma_f32_32x32x16_bf16 v[144:159], v[212:215], v[24:27], v[144:159]
    s_waitcnt lgkmcnt(0)
    s_waitcnt vmcnt(17)
    s_barrier
    v_add_u32 v248, 114688, v246
    v_xor_b32 v249, 32, v248
    v_xor_b32 v250, 64, v248
    v_xor_b32 v251, 0x60, v248
    ds_read_b64_tr_b16 v[192:193], v248 offset:0
    v_add_f32 v230, v230, v116
    ds_read_b64_tr_b16 v[194:195], v249 offset:1024
    v_add_f32 v231, v231, v117
    v_cvt_pk_bf16_f32 v58, v116, v117
    ds_read_b64_tr_b16 v[196:197], v250 offset:0
    s_add_u32 m0, s30, 49152
    s_mov_b32 s41, 49408
    buffer_load_dwordx4 v240, s[52:55], s41 offen nt lds
    buffer_load_dwordx4 v241, s[52:55], s41 offen offset:1024 nt lds
    v_fma_f32 v122, v122, s32, v254
    ds_read_b64_tr_b16 v[198:199], v251 offset:1024
    v_fma_f32 v123, v123, s32, v254
    v_exp_f32 v120, v120
    v_mfma_f32_32x32x16_bf16 v[128:143], v[216:219], v[28:31], v[128:143]
    ds_read_b64_tr_b16 v[200:201], v248 offset:2048
    v_exp_f32 v121, v121
    ds_read_b64_tr_b16 v[202:203], v249 offset:3072
    v_add_f32 v232, v232, v118
    ds_read_b64_tr_b16 v[204:205], v250 offset:2048
    v_add_f32 v233, v233, v119
    ds_read_b64_tr_b16 v[206:207], v251 offset:3072
    v_cvt_pk_bf16_f32 v59, v118, v119
    v_fma_f32 v124, v124, s32, v254
    v_mfma_f32_32x32x16_bf16 v[144:159], v[220:223], v[28:31], v[144:159]
    ds_read_b64_tr_b16 v[208:209], v248 offset:4096
    v_fma_f32 v125, v125, s32, v254
    ds_read_b64_tr_b16 v[210:211], v249 offset:5120
    v_exp_f32 v122, v122
    ds_read_b64_tr_b16 v[212:213], v250 offset:4096
    v_exp_f32 v123, v123
    ds_read_b64_tr_b16 v[214:215], v251 offset:5120
    v_add_f32 v230, v230, v120
    v_add_f32 v231, v231, v121
    s_waitcnt lgkmcnt(8)
    v_mfma_f32_32x32x16_bf16 v[160:175], v[192:195], v[0:3], 0
    ds_read_b64_tr_b16 v[216:217], v248 offset:6144
    v_cvt_pk_bf16_f32 v60, v120, v121
    v_fma_f32 v126, v126, s32, v254
    ds_read_b64_tr_b16 v[218:219], v249 offset:7168
    v_fma_f32 v127, v127, s32, v254
    v_exp_f32 v124, v124
    v_exp_f32 v125, v125
    v_mfma_f32_32x32x16_bf16 v[176:191], v[196:199], v[0:3], 0
    ds_read_b64_tr_b16 v[220:221], v250 offset:6144
    v_add_f32 v232, v232, v122
    v_add_f32 v233, v233, v123
    v_cvt_pk_bf16_f32 v61, v122, v123
    ds_read_b64_tr_b16 v[222:223], v251 offset:7168
    v_fma_f32 v96, v96, s32, v254
    v_fma_f32 v97, v97, s32, v254
    v_exp_f32 v126, v126
    s_waitcnt lgkmcnt(8)
    v_mfma_f32_32x32x16_bf16 v[160:175], v[200:203], v[4:7], v[160:175]
    ds_read_b64_tr_b16 v[192:193], v248 offset:8192
    v_exp_f32 v127, v127
    v_add_f32 v230, v230, v124
    ds_read_b64_tr_b16 v[194:195], v249 offset:9216
    v_add_f32 v231, v231, v125
    v_cvt_pk_bf16_f32 v62, v124, v125
    v_fma_f32 v98, v98, s32, v254
    v_mfma_f32_32x32x16_bf16 v[176:191], v[204:207], v[4:7], v[176:191]
    ds_read_b64_tr_b16 v[196:197], v250 offset:8192
    v_fma_f32 v99, v99, s32, v254
    v_exp_f32 v96, v96
    v_exp_f32 v97, v97
    ds_read_b64_tr_b16 v[198:199], v251 offset:9216
    v_add_f32 v232, v232, v126
    v_add_f32 v233, v233, v127
    s_cmp_eq_u32 s33, 0
    s_cbranch_scc1 L_rs4
    v_mul_f32 v128, v128, v252
    v_mul_f32 v129, v129, v252
    v_mul_f32 v130, v130, v252
    v_mul_f32 v131, v131, v252
    v_mul_f32 v132, v132, v252
    v_mul_f32 v133, v133, v252
    v_mul_f32 v134, v134, v252
    v_mul_f32 v135, v135, v252
    v_mul_f32 v136, v136, v252
    v_mul_f32 v137, v137, v252
    v_mul_f32 v138, v138, v252
    v_mul_f32 v139, v139, v252
    v_mul_f32 v140, v140, v252
    v_mul_f32 v141, v141, v252
    v_mul_f32 v142, v142, v252
    v_mul_f32 v143, v143, v252
    v_mul_f32 v144, v144, v252
    v_mul_f32 v145, v145, v252
    v_mul_f32 v146, v146, v252
    v_mul_f32 v147, v147, v252
    v_mul_f32 v148, v148, v252
    v_mul_f32 v149, v149, v252
    v_mul_f32 v150, v150, v252
    v_mul_f32 v151, v151, v252
    v_mul_f32 v152, v152, v252
    v_mul_f32 v153, v153, v252
    v_mul_f32 v154, v154, v252
    v_mul_f32 v155, v155, v252
    v_mul_f32 v156, v156, v252
    v_mul_f32 v157, v157, v252
    v_mul_f32 v158, v158, v252
    v_mul_f32 v159, v159, v252
L_rs4:
    s_waitcnt lgkmcnt(8)
    v_mfma_f32_32x32x16_bf16 v[160:175], v[208:211], v[8:11], v[160:175]
    ds_read_b64_tr_b16 v[200:201], v248 offset:10240
    v_cvt_pk_bf16_f32 v63, v126, v127
    v_fma_f32 v100, v100, s32, v254
    ds_read_b64_tr_b16 v[202:203], v249 offset:11264
    v_fma_f32 v101, v101, s32, v254
    v_exp_f32 v98, v98
    v_exp_f32 v99, v99
    v_mfma_f32_32x32x16_bf16 v[176:191], v[212:215], v[8:11], v[176:191]
    ds_read_b64_tr_b16 v[204:205], v250 offset:10240
    v_add_f32 v230, v230, v96
    v_add_f32 v231, v231, v97
    v_cvt_pk_bf16_f32 v48, v96, v97
    ds_read_b64_tr_b16 v[206:207], v251 offset:11264
    v_fma_f32 v102, v102, s32, v254
    v_fma_f32 v103, v103, s32, v254
    v_exp_f32 v100, v100
    s_waitcnt lgkmcnt(8)
    v_mfma_f32_32x32x16_bf16 v[160:175], v[216:219], v[12:15], v[160:175]
    ds_read_b64_tr_b16 v[208:209], v248 offset:12288
    v_exp_f32 v101, v101
    v_add_f32 v232, v232, v98
    ds_read_b64_tr_b16 v[210:211], v249 offset:13312
    v_add_f32 v233, v233, v99
    v_cvt_pk_bf16_f32 v49, v98, v99
    v_fma_f32 v104, v104, s32, v254
    v_mfma_f32_32x32x16_bf16 v[176:191], v[220:223], v[12:15], v[176:191]
    ds_read_b64_tr_b16 v[212:213], v250 offset:12288
    v_fma_f32 v105, v105, s32, v254
    v_exp_f32 v102, v102
    ds_read_b64_tr_b16 v[214:215], v251 offset:13312
    v_exp_f32 v103, v103
    v_add_f32 v230, v230, v100
    s_waitcnt lgkmcnt(8)
    v_mfma_f32_32x32x16_bf16 v[160:175], v[192:195], v[16:19], v[160:175]
    ds_read_b64_tr_b16 v[216:217], v248 offset:14336
    v_add_f32 v231, v231, v101
    v_cvt_pk_bf16_f32 v50, v100, v101
    v_fma_f32 v106, v106, s32, v254
    ds_read_b64_tr_b16 v[218:219], v249 offset:15360
    v_fma_f32 v107, v107, s32, v254
    v_exp_f32 v104, v104
    v_exp_f32 v105, v105
    v_mfma_f32_32x32x16_bf16 v[176:191], v[196:199], v[16:19], v[176:191]
    ds_read_b64_tr_b16 v[220:221], v250 offset:14336
    v_add_f32 v232, v232, v102
    v_add_f32 v233, v233, v103
    v_cvt_pk_bf16_f32 v51, v102, v103
    ds_read_b64_tr_b16 v[222:223], v251 offset:15360
    v_fma_f32 v108, v108, s32, v254
    v_fma_f32 v109, v109, s32, v254
    v_exp_f32 v106, v106
    s_waitcnt lgkmcnt(8)
    v_mfma_f32_32x32x16_bf16 v[160:175], v[200:203], v[20:23], v[160:175]
    v_exp_f32 v107, v107
    v_add_f32 v230, v230, v104
    v_add_f32 v231, v231, v105
    v_cvt_pk_bf16_f32 v52, v104, v105
    v_fma_f32 v110, v110, s32, v254
    v_mfma_f32_32x32x16_bf16 v[176:191], v[204:207], v[20:23], v[176:191]
    v_fma_f32 v111, v111, s32, v254
    v_exp_f32 v108, v108
    v_exp_f32 v109, v109
    v_add_f32 v232, v232, v106
    s_waitcnt lgkmcnt(4)
    v_mfma_f32_32x32x16_bf16 v[160:175], v[208:211], v[24:27], v[160:175]
    v_add_f32 v233, v233, v107
    v_cvt_pk_bf16_f32 v53, v106, v107
    v_fma_f32 v80, v80, s32, v254
    v_fma_f32 v81, v81, s32, v254
    v_exp_f32 v110, v110
    v_exp_f32 v111, v111
    v_mfma_f32_32x32x16_bf16 v[176:191], v[212:215], v[24:27], v[176:191]
    s_waitcnt lgkmcnt(0)
    s_waitcnt vmcnt(14)
    s_barrier
    v_mov_b32 v248, v246
    v_xor_b32 v249, 32, v248
    v_xor_b32 v250, 64, v248
    v_xor_b32 v251, 0x60, v248
    ds_read_b64_tr_b16 v[192:193], v248 offset:0
    v_add_f32 v230, v230, v108
    ds_read_b64_tr_b16 v[194:195], v249 offset:1024
    v_add_f32 v231, v231, v109
    v_cvt_pk_bf16_f32 v54, v108, v109
    ds_read_b64_tr_b16 v[196:197], v250 offset:0
    v_fma_f32 v82, v82, s32, v254
    ds_read_b64_tr_b16 v[198:199], v251 offset:1024
    v_fma_f32 v83, v83, s32, v254
    v_exp_f32 v80, v80
    v_mfma_f32_32x32x16_bf16 v[160:175], v[216:219], v[28:31], v[160:175]
    ds_read_b64_tr_b16 v[200:201], v248 offset:2048
    v_exp_f32 v81, v81
    ds_read_b64_tr_b16 v[202:203], v249 offset:3072
    v_add_f32 v232, v232, v110
    ds_read_b64_tr_b16 v[204:205], v250 offset:2048
    v_add_f32 v233, v233, v111
    ds_read_b64_tr_b16 v[206:207], v251 offset:3072
    v_cvt_pk_bf16_f32 v55, v110, v111
    v_mfma_f32_32x32x16_bf16 v[176:191], v[220:223], v[28:31], v[176:191]
    ds_read_b64_tr_b16 v[208:209], v248 offset:4096
    v_fma_f32 v84, v84, s32, v254
    ds_read_b64_tr_b16 v[210:211], v249 offset:5120
    v_fma_f32 v85, v85, s32, v254
    ds_read_b64_tr_b16 v[212:213], v250 offset:4096
    v_exp_f32 v82, v82
    ds_read_b64_tr_b16 v[214:215], v251 offset:5120
    v_exp_f32 v83, v83
    s_waitcnt lgkmcnt(8)
    v_mfma_f32_32x32x16_bf16 v[96:111], v[192:195], v[0:3], 0
    ds_read_b64_tr_b16 v[216:217], v248 offset:6144
    v_add_f32 v230, v230, v80
    v_add_f32 v231, v231, v81
    ds_read_b64_tr_b16 v[218:219], v249 offset:7168
    v_cvt_pk_bf16_f32 v40, v80, v81
    v_fma_f32 v86, v86, s32, v254
    v_mfma_f32_32x32x16_bf16 v[112:127], v[196:199], v[0:3], 0
    ds_read_b64_tr_b16 v[220:221], v250 offset:6144
    v_fma_f32 v87, v87, s32, v254
    ds_read_b64_tr_b16 v[222:223], v251 offset:7168
    v_exp_f32 v84, v84
    v_exp_f32 v85, v85
    s_waitcnt lgkmcnt(8)
    v_mfma_f32_32x32x16_bf16 v[96:111], v[200:203], v[4:7], v[96:111]
    ds_read_b64_tr_b16 v[192:193], v248 offset:8192
    v_add_f32 v232, v232, v82
    v_add_f32 v233, v233, v83
    ds_read_b64_tr_b16 v[194:195], v249 offset:9216
    v_cvt_pk_bf16_f32 v41, v82, v83
    v_fma_f32 v88, v88, s32, v254
    v_fma_f32 v89, v89, s32, v254
    v_mfma_f32_32x32x16_bf16 v[112:127], v[204:207], v[4:7], v[112:127]
    ds_read_b64_tr_b16 v[196:197], v250 offset:8192
    v_exp_f32 v86, v86
    v_exp_f32 v87, v87
    ds_read_b64_tr_b16 v[198:199], v251 offset:9216
    v_add_f32 v230, v230, v84
    s_cmp_eq_u32 s33, 0
    s_cbranch_scc1 L_rs5
    v_mul_f32 v160, v160, v252
    v_mul_f32 v161, v161, v252
    v_mul_f32 v162, v162, v252
    v_mul_f32 v163, v163, v252
    v_mul_f32 v164, v164, v252
    v_mul_f32 v165, v165, v252
    v_mul_f32 v166, v166, v252
    v_mul_f32 v167, v167, v252
    v_mul_f32 v168, v168, v252
    v_mul_f32 v169, v169, v252
    v_mul_f32 v170, v170, v252
    v_mul_f32 v171, v171, v252
    v_mul_f32 v172, v172, v252
    v_mul_f32 v173, v173, v252
    v_mul_f32 v174, v174, v252
    v_mul_f32 v175, v175, v252
    v_mul_f32 v176, v176, v252
    v_mul_f32 v177, v177, v252
    v_mul_f32 v178, v178, v252
    v_mul_f32 v179, v179, v252
    v_mul_f32 v180, v180, v252
    v_mul_f32 v181, v181, v252
    v_mul_f32 v182, v182, v252
    v_mul_f32 v183, v183, v252
    v_mul_f32 v184, v184, v252
    v_mul_f32 v185, v185, v252
    v_mul_f32 v186, v186, v252
    v_mul_f32 v187, v187, v252
    v_mul_f32 v188, v188, v252
    v_mul_f32 v189, v189, v252
    v_mul_f32 v190, v190, v252
    v_mul_f32 v191, v191, v252
L_rs5:
    s_waitcnt lgkmcnt(8)
    v_mfma_f32_32x32x16_bf16 v[96:111], v[208:211], v[8:11], v[96:111]
    ds_read_b64_tr_b16 v[200:201], v248 offset:10240
    v_add_f32 v231, v231, v85
    v_cvt_pk_bf16_f32 v42, v84, v85
    ds_read_b64_tr_b16 v[202:203], v249 offset:11264
    v_fma_f32 v90, v90, s32, v254
    v_fma_f32 v91, v91, s32, v254
    v_exp_f32 v88, v88
    v_mfma_f32_32x32x16_bf16 v[112:127], v[212:215], v[8:11], v[112:127]
    ds_read_b64_tr_b16 v[204:205], v250 offset:10240
    v_exp_f32 v89, v89
    ds_read_b64_tr_b16 v[206:207], v251 offset:11264
    v_add_f32 v232, v232, v86
    v_add_f32 v233, v233, v87
    s_waitcnt lgkmcnt(8)
    v_mfma_f32_32x32x16_bf16 v[96:111], v[216:219], v[12:15], v[96:111]
    ds_read_b64_tr_b16 v[208:209], v248 offset:12288
    v_cvt_pk_bf16_f32 v43, v86, v87
    v_fma_f32 v92, v92, s32, v254
    ds_read_b64_tr_b16 v[210:211], v249 offset:13312
    v_fma_f32 v93, v93, s32, v254
    v_exp_f32 v90, v90
    v_mfma_f32_32x32x16_bf16 v[112:127], v[220:223], v[12:15], v[112:127]
    ds_read_b64_tr_b16 v[212:213], v250 offset:12288
    v_exp_f32 v91, v91
    ds_read_b64_tr_b16 v[214:215], v251 offset:13312
    v_add_f32 v230, v230, v88
    v_add_f32 v231, v231, v89
    s_waitcnt lgkmcnt(8)
    v_mfma_f32_32x32x16_bf16 v[96:111], v[192:195], v[16:19], v[96:111]
    ds_read_b64_tr_b16 v[216:217], v248 offset:14336
    v_cvt_pk_bf16_f32 v44, v88, v89
    v_fma_f32 v94, v94, s32, v254
    ds_read_b64_tr_b16 v[218:219], v249 offset:15360
    v_fma_f32 v95, v95, s32, v254
    v_exp_f32 v92, v92
    v_mfma_f32_32x32x16_bf16 v[112:127], v[196:199], v[16:19], v[112:127]
    ds_read_b64_tr_b16 v[220:221], v250 offset:14336
    v_exp_f32 v93, v93
    v_add_f32 v232, v232, v90
    ds_read_b64_tr_b16 v[222:223], v251 offset:15360
    v_add_f32 v233, v233, v91
    v_cvt_pk_bf16_f32 v45, v90, v91
    s_waitcnt lgkmcnt(8)
    v_mfma_f32_32x32x16_bf16 v[96:111], v[200:203], v[20:23], v[96:111]
    v_fma_f32 v64, v64, s32, v254
    v_fma_f32 v65, v65, s32, v254
    v_exp_f32 v94, v94
    v_exp_f32 v95, v95
    v_mfma_f32_32x32x16_bf16 v[112:127], v[204:207], v[20:23], v[112:127]
    v_add_f32 v230, v230, v92
    v_add_f32 v231, v231, v93
    v_cvt_pk_bf16_f32 v46, v92, v93
    v_fma_f32 v66, v66, s32, v254
    s_waitcnt lgkmcnt(4)
    v_mfma_f32_32x32x16_bf16 v[96:111], v[208:211], v[24:27], v[96:111]
    v_fma_f32 v67, v67, s32, v254
    v_exp_f32 v64, v64
    v_exp_f32 v65, v65
    v_mfma_f32_32x32x16_bf16 v[112:127], v[212:215], v[24:27], v[112:127]
    s_waitcnt lgkmcnt(0)
    s_waitcnt vmcnt(12)
    s_barrier
    v_add_u32 v248, 16384, v246
    v_xor_b32 v249, 32, v248
    v_xor_b32 v250, 64, v248
    v_xor_b32 v251, 0x60, v248
    ds_read_b64_tr_b16 v[192:193], v248 offset:14336
    v_add_f32 v232, v232, v94
    ds_read_b64_tr_b16 v[194:195], v249 offset:15360
    v_add_f32 v233, v233, v95
    ds_read_b64_tr_b16 v[196:197], v250 offset:14336
    v_cvt_pk_bf16_f32 v47, v94, v95
    ds_read_b64_tr_b16 v[198:199], v251 offset:15360
    v_fma_f32 v68, v68, s32, v254
    v_fma_f32 v69, v69, s32, v254
    v_mfma_f32_32x32x16_bf16 v[96:111], v[216:219], v[28:31], v[96:111]
    ds_read_b64_tr_b16 v[200:201], v248 offset:12288
    ds_read_b64_tr_b16 v[202:203], v249 offset:13312
    v_exp_f32 v66, v66
    ds_read_b64_tr_b16 v[204:205], v250 offset:12288
    v_exp_f32 v67, v67
    ds_read_b64_tr_b16 v[206:207], v251 offset:13312
    v_add_f32 v230, v230, v64
    v_mfma_f32_32x32x16_bf16 v[112:127], v[220:223], v[28:31], v[112:127]
    ds_read_b64_tr_b16 v[208:209], v248 offset:10240
    v_add_f32 v231, v231, v65
    ds_read_b64_tr_b16 v[210:211], v249 offset:11264
    v_cvt_pk_bf16_f32 v32, v64, v65
    ds_read_b64_tr_b16 v[212:213], v250 offset:10240
    v_fma_f32 v70, v70, s32, v254
    ds_read_b64_tr_b16 v[214:215], v251 offset:11264
    v_fma_f32 v71, v71, s32, v254
    s_waitcnt lgkmcnt(8)
    v_mfma_f32_32x32x16_bf16 v[128:143], v[192:195], v[60:63], v[128:143]
    ds_read_b64_tr_b16 v[216:217], v248 offset:8192
    v_exp_f32 v68, v68
    ds_read_b64_tr_b16 v[218:219], v249 offset:9216
    v_exp_f32 v69, v69
    v_add_f32 v232, v232, v66
    v_mfma_f32_32x32x16_bf16 v[144:159], v[196:199], v[60:63], v[144:159]
    ds_read_b64_tr_b16 v[220:221], v250 offset:8192
    v_add_f32 v233, v233, v67
    v_cvt_pk_bf16_f32 v33, v66, v67
    ds_read_b64_tr_b16 v[222:223], v251 offset:9216
    v_fma_f32 v72, v72, s32, v254
    v_fma_f32 v73, v73, s32, v254
    v_exp_f32 v70, v70
    s_waitcnt lgkmcnt(8)
    v_mfma_f32_32x32x16_bf16 v[128:143], v[200:203], v[56:59], v[128:143]
    ds_read_b64_tr_b16 v[192:193], v248 offset:6144
    v_exp_f32 v71, v71
    ds_read_b64_tr_b16 v[194:195], v249 offset:7168
    v_add_f32 v230, v230, v68
    v_add_f32 v231, v231, v69
    v_mfma_f32_32x32x16_bf16 v[144:159], v[204:207], v[56:59], v[144:159]
    ds_read_b64_tr_b16 v[196:197], v250 offset:6144
    v_cvt_pk_bf16_f32 v34, v68, v69
    v_fma_f32 v74, v74, s32, v254
    ds_read_b64_tr_b16 v[198:199], v251 offset:7168
    v_fma_f32 v75, v75, s32, v254
    v_exp_f32 v72, v72
    s_cmp_eq_u32 s33, 0
    s_cbranch_scc1 L_rs6
    v_mul_f32 v96, v96, v252
    v_mul_f32 v97, v97, v252
    v_mul_f32 v98, v98, v252
    v_mul_f32 v99, v99, v252
    v_mul_f32 v100, v100, v252
    v_mul_f32 v101, v101, v252
    v_mul_f32 v102, v102, v252
    v_mul_f32 v103, v103, v252
    v_mul_f32 v104, v104, v252
    v_mul_f32 v105, v105, v252
    v_mul_f32 v106, v106, v252
    v_mul_f32 v107, v107, v252
    v_mul_f32 v108, v108, v252
    v_mul_f32 v109, v109, v252
    v_mul_f32 v110, v110, v252
    v_mul_f32 v111, v111, v252
    v_mul_f32 v112, v112, v252
    v_mul_f32 v113, v113, v252
    v_mul_f32 v114, v114, v252
    v_mul_f32 v115, v115, v252
    v_mul_f32 v116, v116, v252
    v_mul_f32 v117, v117, v252
    v_mul_f32 v118, v118, v252
    v_mul_f32 v119, v119, v252
    v_mul_f32 v120, v120, v252
    v_mul_f32 v121, v121, v252
    v_mul_f32 v122, v122, v252
    v_mul_f32 v123, v123, v252
    v_mul_f32 v124, v124, v252
    v_mul_f32 v125, v125, v252
    v_mul_f32 v126, v126, v252
    v_mul_f32 v127, v127, v252
L_rs6:
    s_waitcnt lgkmcnt(8)
    v_mfma_f32_32x32x16_bf16 v[128:143], v[208:211], v[52:55], v[128:143]
    ds_read_b64_tr_b16 v[200:201], v248 offset:4096
    v_exp_f32 v73, v73
    v_add_f32 v232, v232, v70
    ds_read_b64_tr_b16 v[202:203], v249 offset:5120
    v_add_f32 v233, v233, v71
    v_cvt_pk_bf16_f32 v35, v70, v71
    v_mfma_f32_32x32x16_bf16 v[144:159], v[212:215], v[52:55], v[144:159]
    ds_read_b64_tr_b16 v[204:205], v250 offset:4096
    v_fma_f32 v76, v76, s32, v254
    v_fma_f32 v77, v77, s32, v254
    ds_read_b64_tr_b16 v[206:207], v251 offset:5120
    v_exp_f32 v74, v74
    v_exp_f32 v75, v75
    s_waitcnt lgkmcnt(8)
    v_mfma_f32_32x32x16_bf16 v[128:143], v[216:219], v[48:51], v[128:143]
    ds_read_b64_tr_b16 v[208:209], v248 offset:2048
    v_add_f32 v230, v230, v72
    ds_read_b64_tr_b16 v[210:211], v249 offset:3072
    v_add_f32 v231, v231, v73
    v_cvt_pk_bf16_f32 v36, v72, v73
    v_mfma_f32_32x32x16_bf16 v[144:159], v[220:223], v[48:51], v[144:159]
    ds_read_b64_tr_b16 v[212:213], v250 offset:2048
    v_fma_f32 v78, v78, s32, v254
    v_fma_f32 v79, v79, s32, v254
    ds_read_b64_tr_b16 v[214:215], v251 offset:3072
    v_exp_f32 v76, v76
    v_exp_f32 v77, v77
    s_waitcnt lgkmcnt(8)
    v_mfma_f32_32x32x16_bf16 v[128:143], v[192:195], v[44:47], v[128:143]
    ds_read_b64_tr_b16 v[216:217], v248 offset:0
    v_add_f32 v232, v232, v74
    v_add_f32 v233, v233, v75
    ds_read_b64_tr_b16 v[218:219], v249 offset:1024
    v_cvt_pk_bf16_f32 v37, v74, v75
    v_exp_f32 v78, v78
    v_mfma_f32_32x32x16_bf16 v[144:159], v[196:199], v[44:47], v[144:159]
    ds_read_b64_tr_b16 v[220:221], v250 offset:0
    v_exp_f32 v79, v79
    ds_read_b64_tr_b16 v[222:223], v251 offset:1024
    v_add_f32 v230, v230, v76
    v_add_f32 v231, v231, v77
    s_waitcnt lgkmcnt(8)
    v_mfma_f32_32x32x16_bf16 v[128:143], v[200:203], v[40:43], v[128:143]
    v_cvt_pk_bf16_f32 v38, v76, v77
    s_nop 0
    v_add_f32 v232, v232, v78
    v_add_f32 v233, v233, v79
    v_cvt_pk_bf16_f32 v39, v78, v79
    v_mfma_f32_32x32x16_bf16 v[144:159], v[204:207], v[40:43], v[144:159]
    v_add_f32 v230, v230, v232
    v_add_f32 v231, v231, v233
    v_add_f32 v228, v230, v231
    s_waitcnt lgkmcnt(4)
    v_mfma_f32_32x32x16_bf16 v[128:143], v[208:211], v[36:39], v[128:143]
    v_fma_f32 v228, v247, v252, v228
    v_mov_b32 v229, v228
    v_mfma_f32_32x32x16_bf16 v[144:159], v[212:215], v[36:39], v[144:159]
    s_waitcnt lgkmcnt(0)
    s_waitcnt vmcnt(8)
    s_barrier
    v_add_u32 v248, 32768, v246
    v_xor_b32 v249, 32, v248
    v_xor_b32 v250, 64, v248
    v_xor_b32 v251, 0x60, v248
    ds_read_b64_tr_b16 v[192:193], v248 offset:14336
    ds_read_b64_tr_b16 v[194:195], v249 offset:15360
    s_nop 1
    ds_read_b64_tr_b16 v[196:197], v250 offset:14336
    ds_read_b64_tr_b16 v[198:199], v251 offset:15360
    v_permlane32_swap_b32 v228, v229
    v_mfma_f32_32x32x16_bf16 v[128:143], v[216:219], v[32:35], v[128:143]
    ds_read_b64_tr_b16 v[200:201], v248 offset:12288
    ds_read_b64_tr_b16 v[202:203], v249 offset:13312
    s_nop 0
    ds_read_b64_tr_b16 v[204:205], v250 offset:12288
    ds_read_b64_tr_b16 v[206:207], v251 offset:13312
    v_add_f32 v228, v228, v229
    v_mfma_f32_32x32x16_bf16 v[144:159], v[220:223], v[32:35], v[144:159]
    ds_read_b64_tr_b16 v[208:209], v248 offset:10240
    ds_read_b64_tr_b16 v[210:211], v249 offset:11264
    ds_read_b64_tr_b16 v[212:213], v250 offset:10240
    ds_read_b64_tr_b16 v[214:215], v251 offset:11264
    v_rcp_f32 v254, v228
    s_waitcnt lgkmcnt(8)
    v_mfma_f32_32x32x16_bf16 v[160:175], v[192:195], v[60:63], v[160:175]
    ds_read_b64_tr_b16 v[216:217], v248 offset:8192
    ds_read_b64_tr_b16 v[218:219], v249 offset:9216
    v_mfma_f32_32x32x16_bf16 v[176:191], v[196:199], v[60:63], v[176:191]
    ds_read_b64_tr_b16 v[220:221], v250 offset:8192
    v_mul_f32 v128, v128, v254
    v_mul_f32 v129, v129, v254
    v_mul_f32 v130, v130, v254
    ds_read_b64_tr_b16 v[222:223], v251 offset:9216
    v_mul_f32 v131, v131, v254
    v_cvt_pk_bf16_f32 v128, v128, v129
    v_cvt_pk_bf16_f32 v129, v130, v131
    ds_write_b64 v243, v[128:129]
    s_waitcnt lgkmcnt(9)
    v_mfma_f32_32x32x16_bf16 v[160:175], v[200:203], v[56:59], v[160:175]
    ds_read_b64_tr_b16 v[192:193], v248 offset:6144
    v_mul_f32 v132, v132, v254
    v_mul_f32 v133, v133, v254
    v_mul_f32 v134, v134, v254
    v_mul_f32 v135, v135, v254
    ds_read_b64_tr_b16 v[194:195], v249 offset:7168
    v_cvt_pk_bf16_f32 v132, v132, v133
    v_cvt_pk_bf16_f32 v133, v134, v135
    v_xor_b32 v134, 16, v243
    ds_write_b64 v134, v[132:133]
    v_mfma_f32_32x32x16_bf16 v[176:191], v[204:207], v[56:59], v[176:191]
    ds_read_b64_tr_b16 v[196:197], v250 offset:6144
    v_mul_f32 v136, v136, v254
    v_mul_f32 v137, v137, v254
    v_mul_f32 v138, v138, v254
    v_mul_f32 v139, v139, v254
    ds_read_b64_tr_b16 v[198:199], v251 offset:7168
    v_cvt_pk_bf16_f32 v136, v136, v137
    v_cvt_pk_bf16_f32 v137, v138, v139
    v_xor_b32 v138, 32, v243
    ds_write_b64 v138, v[136:137]
    s_waitcnt lgkmcnt(11)
    v_mfma_f32_32x32x16_bf16 v[160:175], v[208:211], v[52:55], v[160:175]
    ds_read_b64_tr_b16 v[200:201], v248 offset:4096
    v_mul_f32 v140, v140, v254
    v_mul_f32 v141, v141, v254
    v_mul_f32 v142, v142, v254
    v_mul_f32 v143, v143, v254
    ds_read_b64_tr_b16 v[202:203], v249 offset:5120
    v_cvt_pk_bf16_f32 v140, v140, v141
    v_cvt_pk_bf16_f32 v141, v142, v143
    v_xor_b32 v142, 48, v243
    ds_write_b64 v142, v[140:141]
    v_mfma_f32_32x32x16_bf16 v[176:191], v[212:215], v[52:55], v[176:191]
    ds_read_b64_tr_b16 v[204:205], v250 offset:4096
    v_mul_f32 v144, v144, v254
    v_mul_f32 v145, v145, v254
    v_mul_f32 v146, v146, v254
    v_mul_f32 v147, v147, v254
    ds_read_b64_tr_b16 v[206:207], v251 offset:5120
    v_cvt_pk_bf16_f32 v144, v144, v145
    v_cvt_pk_bf16_f32 v145, v146, v147
    v_xor_b32 v146, 64, v243
    ds_write_b64 v146, v[144:145]
    s_waitcnt lgkmcnt(13)
    v_mfma_f32_32x32x16_bf16 v[160:175], v[216:219], v[48:51], v[160:175]
    ds_read_b64_tr_b16 v[208:209], v248 offset:2048
    v_mul_f32 v148, v148, v254
    v_mul_f32 v149, v149, v254
    v_mul_f32 v150, v150, v254
    v_mul_f32 v151, v151, v254
    ds_read_b64_tr_b16 v[210:211], v249 offset:3072
    v_cvt_pk_bf16_f32 v148, v148, v149
    v_cvt_pk_bf16_f32 v149, v150, v151
    v_xor_b32 v150, 80, v243
    ds_write_b64 v150, v[148:149]
    v_mfma_f32_32x32x16_bf16 v[176:191], v[220:223], v[48:51], v[176:191]
    ds_read_b64_tr_b16 v[212:213], v250 offset:2048
    v_mul_f32 v152, v152, v254
    v_mul_f32 v153, v153, v254
    v_mul_f32 v154, v154, v254
    v_mul_f32 v155, v155, v254
    ds_read_b64_tr_b16 v[214:215], v251 offset:3072
    v_cvt_pk_bf16_f32 v152, v152, v153
    v_cvt_pk_bf16_f32 v153, v154, v155
    v_xor_b32 v154, 96, v243
    ds_write_b64 v154, v[152:153]
    s_waitcnt lgkmcnt(13)
    v_mfma_f32_32x32x16_bf16 v[160:175], v[192:195], v[44:47], v[160:175]
    ds_read_b64_tr_b16 v[216:217], v248 offset:0
    v_mul_f32 v156, v156, v254
    v_mul_f32 v157, v157, v254
    v_mul_f32 v158, v158, v254
    v_mul_f32 v159, v159, v254
    ds_read_b64_tr_b16 v[218:219], v249 offset:1024
    v_cvt_pk_bf16_f32 v156, v156, v157
    v_cvt_pk_bf16_f32 v157, v158, v159
    v_xor_b32 v158, 112, v243
    ds_write_b64 v158, v[156:157]
    v_mfma_f32_32x32x16_bf16 v[176:191], v[196:199], v[44:47], v[176:191]
    ds_read_b64_tr_b16 v[220:221], v250 offset:0
    ds_read_b64_tr_b16 v[222:223], v251 offset:1024
    s_waitcnt lgkmcnt(12)
    v_mfma_f32_32x32x16_bf16 v[160:175], v[200:203], v[40:43], v[160:175]
    ds_read_b128 v[64:67], v244 offset:0
    ds_read_b128 v[68:71], v244 offset:1024
    v_mfma_f32_32x32x16_bf16 v[176:191], v[204:207], v[40:43], v[176:191]
    ds_read_b128 v[72:75], v244 offset:2048
    ds_read_b128 v[76:79], v244 offset:3072
    s_waitcnt lgkmcnt(10)
    v_mfma_f32_32x32x16_bf16 v[160:175], v[208:211], v[36:39], v[160:175]
    s_waitcnt lgkmcnt(3)
    buffer_store_dwordx4 v[64:67], v242, s[76:79], s36 offen sc0 sc1
    v_mfma_f32_32x32x16_bf16 v[176:191], v[212:215], v[36:39], v[176:191]
    s_waitcnt vmcnt(1)
    s_barrier
    v_add_u32 v248, 49152, v246
    v_xor_b32 v249, 32, v248
    v_xor_b32 v250, 64, v248
    v_xor_b32 v251, 0x60, v248
    ds_read_b64_tr_b16 v[192:193], v248 offset:14336
    ds_read_b64_tr_b16 v[194:195], v249 offset:15360
    ds_read_b64_tr_b16 v[196:197], v250 offset:14336
    ds_read_b64_tr_b16 v[198:199], v251 offset:15360
    s_waitcnt lgkmcnt(6)
    buffer_store_dwordx4 v[68:71], v242, s[76:79], s37 offen sc0 sc1
    v_mfma_f32_32x32x16_bf16 v[160:175], v[216:219], v[32:35], v[160:175]
    ds_read_b64_tr_b16 v[200:201], v248 offset:12288
    ds_read_b64_tr_b16 v[202:203], v249 offset:13312
    ds_read_b64_tr_b16 v[204:205], v250 offset:12288
    ds_read_b64_tr_b16 v[206:207], v251 offset:13312
    s_waitcnt lgkmcnt(9)
    buffer_store_dwordx4 v[72:75], v242, s[76:79], s38 offen sc0 sc1
    v_mfma_f32_32x32x16_bf16 v[176:191], v[220:223], v[32:35], v[176:191]
    ds_read_b64_tr_b16 v[208:209], v248 offset:10240
    ds_read_b64_tr_b16 v[210:211], v249 offset:11264
    ds_read_b64_tr_b16 v[212:213], v250 offset:10240
    ds_read_b64_tr_b16 v[214:215], v251 offset:11264
    s_waitcnt lgkmcnt(12)
    buffer_store_dwordx4 v[76:79], v242, s[76:79], s39 offen sc0 sc1
    s_waitcnt lgkmcnt(8)
    v_mfma_f32_32x32x16_bf16 v[96:111], v[192:195], v[60:63], v[96:111]
    ds_read_b64_tr_b16 v[216:217], v248 offset:8192
    ds_read_b64_tr_b16 v[218:219], v249 offset:9216
    v_mfma_f32_32x32x16_bf16 v[112:127], v[196:199], v[60:63], v[112:127]
    ds_read_b64_tr_b16 v[220:221], v250 offset:8192
    ds_read_b64_tr_b16 v[222:223], v251 offset:9216
    s_waitcnt lgkmcnt(8)
    v_mfma_f32_32x32x16_bf16 v[96:111], v[200:203], v[56:59], v[96:111]
    ds_read_b64_tr_b16 v[192:193], v248 offset:6144
    v_mul_f32 v160, v160, v254
    v_mul_f32 v161, v161, v254
    v_mul_f32 v162, v162, v254
    ds_read_b64_tr_b16 v[194:195], v249 offset:7168
    v_mul_f32 v163, v163, v254
    v_cvt_pk_bf16_f32 v160, v160, v161
    v_cvt_pk_bf16_f32 v161, v162, v163
    ds_write_b64 v243, v[160:161]
    v_mfma_f32_32x32x16_bf16 v[112:127], v[204:207], v[56:59], v[112:127]
    ds_read_b64_tr_b16 v[196:197], v250 offset:6144
    v_mul_f32 v164, v164, v254
    v_mul_f32 v165, v165, v254
    v_mul_f32 v166, v166, v254
    v_mul_f32 v167, v167, v254
    ds_read_b64_tr_b16 v[198:199], v251 offset:7168
    v_cvt_pk_bf16_f32 v164, v164, v165
    v_cvt_pk_bf16_f32 v165, v166, v167
    v_xor_b32 v166, 16, v243
    ds_write_b64 v166, v[164:165]
    s_waitcnt lgkmcnt(10)
    v_mfma_f32_32x32x16_bf16 v[96:111], v[208:211], v[52:55], v[96:111]
    ds_read_b64_tr_b16 v[200:201], v248 offset:4096
    v_mul_f32 v168, v168, v254
    v_mul_f32 v169, v169, v254
    v_mul_f32 v170, v170, v254
    v_mul_f32 v171, v171, v254
    ds_read_b64_tr_b16 v[202:203], v249 offset:5120
    v_cvt_pk_bf16_f32 v168, v168, v169
    v_cvt_pk_bf16_f32 v169, v170, v171
    v_xor_b32 v170, 32, v243
    ds_write_b64 v170, v[168:169]
    v_mfma_f32_32x32x16_bf16 v[112:127], v[212:215], v[52:55], v[112:127]
    ds_read_b64_tr_b16 v[204:205], v250 offset:4096
    v_mul_f32 v172, v172, v254
    v_mul_f32 v173, v173, v254
    v_mul_f32 v174, v174, v254
    v_mul_f32 v175, v175, v254
    ds_read_b64_tr_b16 v[206:207], v251 offset:5120
    v_cvt_pk_bf16_f32 v172, v172, v173
    v_cvt_pk_bf16_f32 v173, v174, v175
    v_xor_b32 v174, 48, v243
    ds_write_b64 v174, v[172:173]
    s_waitcnt lgkmcnt(12)
    v_mfma_f32_32x32x16_bf16 v[96:111], v[216:219], v[48:51], v[96:111]
    ds_read_b64_tr_b16 v[208:209], v248 offset:2048
    v_mul_f32 v176, v176, v254
    v_mul_f32 v177, v177, v254
    v_mul_f32 v178, v178, v254
    v_mul_f32 v179, v179, v254
    ds_read_b64_tr_b16 v[210:211], v249 offset:3072
    v_cvt_pk_bf16_f32 v176, v176, v177
    v_cvt_pk_bf16_f32 v177, v178, v179
    v_xor_b32 v178, 64, v243
    ds_write_b64 v178, v[176:177]
    v_mfma_f32_32x32x16_bf16 v[112:127], v[220:223], v[48:51], v[112:127]
    ds_read_b64_tr_b16 v[212:213], v250 offset:2048
    v_mul_f32 v180, v180, v254
    v_mul_f32 v181, v181, v254
    v_mul_f32 v182, v182, v254
    v_mul_f32 v183, v183, v254
    ds_read_b64_tr_b16 v[214:215], v251 offset:3072
    v_cvt_pk_bf16_f32 v180, v180, v181
    v_cvt_pk_bf16_f32 v181, v182, v183
    v_xor_b32 v182, 80, v243
    ds_write_b64 v182, v[180:181]
    s_waitcnt lgkmcnt(13)
    v_mfma_f32_32x32x16_bf16 v[96:111], v[192:195], v[44:47], v[96:111]
    ds_read_b64_tr_b16 v[216:217], v248 offset:0
    v_mul_f32 v184, v184, v254
    v_mul_f32 v185, v185, v254
    v_mul_f32 v186, v186, v254
    v_mul_f32 v187, v187, v254
    ds_read_b64_tr_b16 v[218:219], v249 offset:1024
    v_cvt_pk_bf16_f32 v184, v184, v185
    v_cvt_pk_bf16_f32 v185, v186, v187
    v_xor_b32 v186, 96, v243
    ds_write_b64 v186, v[184:185]
    v_mfma_f32_32x32x16_bf16 v[112:127], v[196:199], v[44:47], v[112:127]
    ds_read_b64_tr_b16 v[220:221], v250 offset:0
    v_mul_f32 v188, v188, v254
    v_mul_f32 v189, v189, v254
    v_mul_f32 v190, v190, v254
    v_mul_f32 v191, v191, v254
    ds_read_b64_tr_b16 v[222:223], v251 offset:1024
    v_cvt_pk_bf16_f32 v188, v188, v189
    v_cvt_pk_bf16_f32 v189, v190, v191
    v_xor_b32 v190, 112, v243
    ds_write_b64 v190, v[188:189]
    s_waitcnt lgkmcnt(13)
    v_mfma_f32_32x32x16_bf16 v[96:111], v[200:203], v[40:43], v[96:111]
    ds_read_b128 v[160:163], v244 offset:0
    ds_read_b128 v[164:167], v244 offset:1024
    v_mfma_f32_32x32x16_bf16 v[112:127], v[204:207], v[40:43], v[112:127]
    ds_read_b128 v[168:171], v244 offset:2048
    ds_read_b128 v[172:175], v244 offset:3072
    s_waitcnt lgkmcnt(11)
    v_mfma_f32_32x32x16_bf16 v[96:111], v[208:211], v[36:39], v[96:111]
    s_waitcnt lgkmcnt(3)
    buffer_store_dwordx4 v[160:163], v242, s[76:79], s36 offen offset:128 sc0 sc1
    v_mfma_f32_32x32x16_bf16 v[112:127], v[212:215], v[36:39], v[112:127]
    s_waitcnt lgkmcnt(2)
    buffer_store_dwordx4 v[164:167], v242, s[76:79], s37 offen offset:128 sc0 sc1
    v_mfma_f32_32x32x16_bf16 v[96:111], v[216:219], v[32:35], v[96:111]
    s_waitcnt lgkmcnt(1)
    buffer_store_dwordx4 v[168:171], v242, s[76:79], s38 offen offset:128 sc0 sc1
    v_mfma_f32_32x32x16_bf16 v[112:127], v[220:223], v[32:35], v[112:127]
    s_waitcnt lgkmcnt(0)
    buffer_store_dwordx4 v[172:175], v242, s[76:79], s39 offen offset:128 sc0 sc1
    s_nop 15
    v_pk_mul_f32 v[96:97], v[96:97], v[254:255] op_sel_hi:[1,0]
    v_pk_mul_f32 v[98:99], v[98:99], v[254:255] op_sel_hi:[1,0]
    v_cvt_pk_bf16_f32 v96, v96, v97
    v_cvt_pk_bf16_f32 v97, v98, v99
    ds_write_b64 v243, v[96:97]
    v_pk_mul_f32 v[100:101], v[100:101], v[254:255] op_sel_hi:[1,0]
    v_pk_mul_f32 v[102:103], v[102:103], v[254:255] op_sel_hi:[1,0]
    v_cvt_pk_bf16_f32 v100, v100, v101
    v_cvt_pk_bf16_f32 v101, v102, v103
    v_xor_b32 v102, 16, v243
    ds_write_b64 v102, v[100:101]
    v_pk_mul_f32 v[104:105], v[104:105], v[254:255] op_sel_hi:[1,0]
    v_pk_mul_f32 v[106:107], v[106:107], v[254:255] op_sel_hi:[1,0]
    v_cvt_pk_bf16_f32 v104, v104, v105
    v_cvt_pk_bf16_f32 v105, v106, v107
    v_xor_b32 v106, 32, v243
    ds_write_b64 v106, v[104:105]
    v_pk_mul_f32 v[108:109], v[108:109], v[254:255] op_sel_hi:[1,0]
    v_pk_mul_f32 v[110:111], v[110:111], v[254:255] op_sel_hi:[1,0]
    v_cvt_pk_bf16_f32 v108, v108, v109
    v_cvt_pk_bf16_f32 v109, v110, v111
    v_xor_b32 v110, 48, v243
    ds_write_b64 v110, v[108:109]
    v_pk_mul_f32 v[112:113], v[112:113], v[254:255] op_sel_hi:[1,0]
    v_pk_mul_f32 v[114:115], v[114:115], v[254:255] op_sel_hi:[1,0]
    v_cvt_pk_bf16_f32 v112, v112, v113
    v_cvt_pk_bf16_f32 v113, v114, v115
    v_xor_b32 v114, 64, v243
    ds_write_b64 v114, v[112:113]
    v_pk_mul_f32 v[116:117], v[116:117], v[254:255] op_sel_hi:[1,0]
    v_pk_mul_f32 v[118:119], v[118:119], v[254:255] op_sel_hi:[1,0]
    v_cvt_pk_bf16_f32 v116, v116, v117
    v_cvt_pk_bf16_f32 v117, v118, v119
    v_xor_b32 v118, 80, v243
    ds_write_b64 v118, v[116:117]
    v_pk_mul_f32 v[120:121], v[120:121], v[254:255] op_sel_hi:[1,0]
    v_pk_mul_f32 v[122:123], v[122:123], v[254:255] op_sel_hi:[1,0]
    v_cvt_pk_bf16_f32 v120, v120, v121
    v_cvt_pk_bf16_f32 v121, v122, v123
    v_xor_b32 v122, 96, v243
    ds_write_b64 v122, v[120:121]
    v_pk_mul_f32 v[124:125], v[124:125], v[254:255] op_sel_hi:[1,0]
    v_pk_mul_f32 v[126:127], v[126:127], v[254:255] op_sel_hi:[1,0]
    v_cvt_pk_bf16_f32 v124, v124, v125
    v_cvt_pk_bf16_f32 v125, v126, v127
    v_xor_b32 v126, 112, v243
    ds_write_b64 v126, v[124:125]
    ds_read_b128 v[224:227], v244 offset:0
    ds_read_b128 v[228:231], v244 offset:1024
    ds_read_b128 v[232:235], v244 offset:2048
    ds_read_b128 v[236:239], v244 offset:3072
    s_waitcnt lgkmcnt(3)
    buffer_store_dwordx4 v[224:227], v242, s[76:79], s36 offen offset:256 sc0 sc1
    s_waitcnt lgkmcnt(2)
    buffer_store_dwordx4 v[228:231], v242, s[76:79], s37 offen offset:256 sc0 sc1
    s_waitcnt lgkmcnt(1)
    buffer_store_dwordx4 v[232:235], v242, s[76:79], s38 offen offset:256 sc0 sc1
    s_waitcnt lgkmcnt(0)
    buffer_store_dwordx4 v[236:239], v242, s[76:79], s39 offen offset:256 sc0 sc1
    s_waitcnt vmcnt(0)
L_end:
    s_endpgm
.section .rodata,"a"
.p2align 6
.amdhsa_kernel standalone__mha_softmax__near_ridge_kernel
  .amdhsa_next_free_vgpr 256
  .amdhsa_next_free_sgpr 88
  .amdhsa_accum_offset 256
  .amdhsa_group_segment_fixed_size 0
  .amdhsa_kernarg_size 48
  .amdhsa_user_sgpr_count 2
  .amdhsa_user_sgpr_kernarg_segment_ptr 1
  .amdhsa_system_sgpr_workgroup_id_x 1
.end_amdhsa_kernel
```
